```python
import torch

def _softmax(x, axis=-1):
    return torch.softmax(x, dim=axis)
def _gelu(x):
    return torch.nn.functional.gelu(x, approximate="tanh")
def _silu(x):
    return torch.nn.functional.silu(x)
def _sigmoid(x):
    return torch.sigmoid(x)
def _layernorm(x, axis=-1, eps=1e-5):
    m = x.mean(dim=axis, keepdim=True)
    v = x.var(dim=axis, keepdim=True, unbiased=False)
    return (x - m) / torch.sqrt(v + eps)
def _scatter_add(tgt, idx, src, axis=0):
    return tgt.clone().index_add_(axis, idx, src)
def _segment_sum(src, seg, n):
    out = torch.zeros((n,) + src.shape[1:], dtype=src.dtype)
    return out.index_add_(0, seg, src)
def _pad(x, pw):
    flat = tuple(v for pair in reversed(pw) for v in pair)
    return torch.nn.functional.pad(x, flat)

kernel_name = 'standalone__gqa_softmax__near_ridge'

def setup_inputs():

    _w = (lambda a: (lambda t: t.to(torch.bfloat16) if t.is_floating_point() else t)(torch.as_tensor(a)))
    B, Hq, Hkv, Sq, Sk, D = 8, 32, 32, 240, 1024, 128
    return {
        "q": _w((lambda *s: torch.randn(*s, dtype=torch.bfloat16) * 0.8)(B, Hq, Sq, D)),
        "k": _w((lambda *s: torch.randn(*s, dtype=torch.bfloat16) * 0.8)(B, Hkv, Sk, D)),
        "v": _w((lambda *s: torch.randn(*s, dtype=torch.bfloat16) * 0.05)(B, Hkv, Sk, D)),
    }

def reference(q, k, v):
    B, Hq, Sq, D = q.shape
    Hkv = k.shape[1]
    rep = Hq // Hkv
    k = (lambda x, n, axis: torch.repeat_interleave(x, n, dim=axis))(k, rep, axis=1)
    v = (lambda x, n, axis: torch.repeat_interleave(x, n, dim=axis))(v, rep, axis=1)
    scale = D ** -0.5
    scores = torch.einsum("bhqd,bhkd->bhqk", q, k) * scale
    p = _softmax(scores, axis=-1)
    return torch.einsum("bhqk,bhkd->bhqd", p, v)
```

```asm
; @launch grid=(256,1,1) block=(512,1,1) lds=131072
.amdgcn_target "amdgcn-amd-amdhsa--gfx950"
.text
.globl standalone__gqa_softmax__near_ridge_kernel
.p2align 8
.type standalone__gqa_softmax__near_ridge_kernel,@function
standalone__gqa_softmax__near_ridge_kernel:
    s_cmp_ge_u32 s2, 256
    s_cbranch_scc1 L_end
    s_load_dwordx4 s[32:35], s[0:1], 0
    s_load_dwordx4 s[36:39], s[0:1], 16
    v_lshrrev_b32 v5, 6, v0
    s_nop 0
    v_readfirstlane_b32 s26, v5
    v_and_b32 v0, 63, v0
    s_mul_i32 s27, s2, 61440
    s_lshl_b32 s31, s2, 18
    s_waitcnt lgkmcnt(0)
    s_add_u32 s4, s32, s27
    s_addc_u32 s5, s33, 0
    s_mov_b32 s6, 61440
    s_mov_b32 s7, 0x00020000
    s_add_u32 s8, s34, s31
    s_addc_u32 s9, s35, 0
    s_mov_b32 s10, 262144
    s_mov_b32 s11, 0x00020000
    s_add_u32 s12, s36, s31
    s_addc_u32 s13, s37, 0
    s_mov_b32 s14, 262144
    s_mov_b32 s15, 0x00020000
    s_add_u32 s16, s38, s27
    s_addc_u32 s17, s39, 0
    s_mov_b32 s18, 61440
    s_mov_b32 s19, 0x00020000
    s_mov_b32 s25, 0x3e0293ee
    s_mov_b32 s30, 0x427af233
    v_and_b32 v5, 31, v0
    v_lshrrev_b32 v6, 5, v0
    s_lshl_b32 s27, s26, 13
    v_lshlrev_b32 v7, 8, v5
    v_add_u32 v7, s27, v7
    v_lshl_add_u32 v4, v6, 4, v7
    v_lshl_add_u32 v237, v6, 4, v7
    buffer_load_dwordx4 v[8:11], v4, s[4:7], 0 offen offset:0
    buffer_load_dwordx4 v[12:15], v4, s[4:7], 0 offen offset:32
    buffer_load_dwordx4 v[16:19], v4, s[4:7], 0 offen offset:64
    buffer_load_dwordx4 v[20:23], v4, s[4:7], 0 offen offset:96
    buffer_load_dwordx4 v[24:27], v4, s[4:7], 0 offen offset:128
    buffer_load_dwordx4 v[28:31], v4, s[4:7], 0 offen offset:160
    buffer_load_dwordx4 v[32:35], v4, s[4:7], 0 offen offset:192
    buffer_load_dwordx4 v[36:39], v4, s[4:7], 0 offen offset:224
    v_and_b32 v7, 15, v5
    v_xor_b32 v7, v6, v7
    v_lshlrev_b32 v7, 4, v7
    v_lshl_add_u32 v235, v5, 8, v7
    v_and_b32 v5, 15, v0
    v_lshrrev_b32 v7, 2, v5
    v_and_b32 v5, 3, v5
    v_lshlrev_b32 v5, 3, v5
    v_lshl_add_u32 v5, v7, 6, v5
    v_lshl_add_u32 v5, v7, 8, v5
    v_lshl_add_u32 v5, v6, 10, v5
    v_bfe_u32 v7, v0, 4, 1
    v_lshl_add_u32 v236, v7, 5, v5
    v_lshrrev_b32 v5, 4, v0
    v_and_b32 v6, 15, v0
    s_lshl_b32 s27, s26, 3
    v_add_u32 v7, s27, v5
    v_and_b32 v4, 15, v7
    v_xor_b32 v4, v4, v6
    v_lshlrev_b32 v4, 4, v4
    v_lshl_add_u32 v232, v7, 8, v4
    v_add_u32 v4, 4, v7
    v_and_b32 v4, 15, v4
    v_xor_b32 v4, v4, v6
    v_lshlrev_b32 v4, 4, v4
    v_lshl_add_u32 v233, v7, 8, v4
    v_lshlrev_b32 v4, 2, v5
    v_xor_b32 v4, v4, v6
    v_lshlrev_b32 v4, 4, v4
    v_lshl_add_u32 v234, v7, 8, v4
    s_lshl_b32 s28, s26, 11
    s_add_u32 s29, s28, 16384
    s_mov_b32 s21, 0
    s_mov_b32 s24, 0
    s_mov_b32 s22, 0
    s_mov_b32 s23, 0
    s_add_u32 m0, s24, s28
    s_nop 0
    buffer_load_dwordx4 v232, s[8:11], s21 offen nt lds
    buffer_load_dwordx4 v233, s[8:11], s21 offen offset:1024 nt lds
    s_add_u32 m0, s24, s29
    s_nop 0
    buffer_load_dwordx4 v234, s[12:15], s21 offen nt lds
    buffer_load_dwordx4 v234, s[12:15], s21 offen offset:1024 nt lds
    s_add_u32 s21, s21, 16384
    s_add_u32 s24, s24, 32768
    s_cmp_ge_u32 s24, 131072
    s_cselect_b32 s24, 0, s24
    s_add_u32 m0, s24, s28
    s_nop 0
    buffer_load_dwordx4 v232, s[8:11], s21 offen nt lds
    buffer_load_dwordx4 v233, s[8:11], s21 offen offset:1024 nt lds
    s_add_u32 m0, s24, s29
    s_nop 0
    buffer_load_dwordx4 v234, s[12:15], s21 offen nt lds
    buffer_load_dwordx4 v234, s[12:15], s21 offen offset:1024 nt lds
    s_add_u32 s21, s21, 16384
    s_add_u32 s24, s24, 32768
    s_cmp_ge_u32 s24, 131072
    s_cselect_b32 s24, 0, s24
    s_add_u32 m0, s24, s28
    s_nop 0
    buffer_load_dwordx4 v232, s[8:11], s21 offen nt lds
    buffer_load_dwordx4 v233, s[8:11], s21 offen offset:1024 nt lds
    s_add_u32 m0, s24, s29
    s_nop 0
    buffer_load_dwordx4 v234, s[12:15], s21 offen nt lds
    buffer_load_dwordx4 v234, s[12:15], s21 offen offset:1024 nt lds
    s_add_u32 s21, s21, 16384
    s_add_u32 s24, s24, 32768
    s_cmp_ge_u32 s24, 131072
    s_cselect_b32 s24, 0, s24
    v_mov_b32 v1, 0xff800000
    v_mov_b32 v238, 0
    v_mov_b32 v2, 0
    v_mov_b32 v3, 0
    v_mov_b32 v40, 0
    v_mov_b32 v41, 0
    v_mov_b32 v42, 0
    v_mov_b32 v43, 0
    v_mov_b32 v44, 0
    v_mov_b32 v45, 0
    v_mov_b32 v46, 0
    v_mov_b32 v47, 0
    v_mov_b32 v48, 0
    v_mov_b32 v49, 0
    v_mov_b32 v50, 0
    v_mov_b32 v51, 0
    v_mov_b32 v52, 0
    v_mov_b32 v53, 0
    v_mov_b32 v54, 0
    v_mov_b32 v55, 0
    v_mov_b32 v56, 0
    v_mov_b32 v57, 0
    v_mov_b32 v58, 0
    v_mov_b32 v59, 0
    v_mov_b32 v60, 0
    v_mov_b32 v61, 0
    v_mov_b32 v62, 0
    v_mov_b32 v63, 0
    v_mov_b32 v64, 0
    v_mov_b32 v65, 0
    v_mov_b32 v66, 0
    v_mov_b32 v67, 0
    v_mov_b32 v68, 0
    v_mov_b32 v69, 0
    v_mov_b32 v70, 0
    v_mov_b32 v71, 0
    v_mov_b32 v72, 0
    v_mov_b32 v73, 0
    v_mov_b32 v74, 0
    v_mov_b32 v75, 0
    v_mov_b32 v76, 0
    v_mov_b32 v77, 0
    v_mov_b32 v78, 0
    v_mov_b32 v79, 0
    v_mov_b32 v80, 0
    v_mov_b32 v81, 0
    v_mov_b32 v82, 0
    v_mov_b32 v83, 0
    v_mov_b32 v84, 0
    v_mov_b32 v85, 0
    v_mov_b32 v86, 0
    v_mov_b32 v87, 0
    v_mov_b32 v88, 0
    v_mov_b32 v89, 0
    v_mov_b32 v90, 0
    v_mov_b32 v91, 0
    v_mov_b32 v92, 0
    v_mov_b32 v93, 0
    v_mov_b32 v94, 0
    v_mov_b32 v95, 0
    v_mov_b32 v96, 0
    v_mov_b32 v97, 0
    v_mov_b32 v98, 0
    v_mov_b32 v99, 0
    v_mov_b32 v100, 0
    v_mov_b32 v101, 0
    v_mov_b32 v102, 0
    v_mov_b32 v103, 0
    s_waitcnt vmcnt(8)
    s_barrier
    v_add_u32 v239, s22, v235
    v_xor_b32 v240, 32, v239
    v_xor_b32 v241, 64, v239
    v_xor_b32 v242, 96, v239
    v_xor_b32 v243, 128, v239
    v_xor_b32 v244, 160, v239
    v_xor_b32 v245, 192, v239
    v_xor_b32 v246, 224, v239
    ds_read_b128 v[184:187], v239 offset:0
    ds_read_b128 v[188:191], v239 offset:8192
    ds_read_b128 v[192:195], v240 offset:0
    ds_read_b128 v[196:199], v240 offset:8192
    ds_read_b128 v[200:203], v241 offset:0
    ds_read_b128 v[204:207], v241 offset:8192
    ds_read_b128 v[208:211], v242 offset:0
    ds_read_b128 v[212:215], v242 offset:8192
    ds_read_b128 v[216:219], v243 offset:0
    ds_read_b128 v[220:223], v243 offset:8192
    ds_read_b128 v[224:227], v244 offset:0
    ds_read_b128 v[228:231], v244 offset:8192
    s_waitcnt lgkmcnt(11)
    v_mfma_f32_32x32x16_bf16 v[104:119], v[184:187], v[8:11], 0
    ds_read_b128 v[184:187], v245 offset:0
    s_waitcnt lgkmcnt(11)
    v_mfma_f32_32x32x16_bf16 v[120:135], v[188:191], v[8:11], 0
    ds_read_b128 v[188:191], v245 offset:8192
    s_waitcnt lgkmcnt(11)
    v_mfma_f32_32x32x16_bf16 v[104:119], v[192:195], v[12:15], v[104:119]
    ds_read_b128 v[192:195], v246 offset:0
    s_waitcnt lgkmcnt(11)
    v_mfma_f32_32x32x16_bf16 v[120:135], v[196:199], v[12:15], v[120:135]
    ds_read_b128 v[196:199], v246 offset:8192
    s_waitcnt lgkmcnt(11)
    v_mfma_f32_32x32x16_bf16 v[104:119], v[200:203], v[16:19], v[104:119]
    s_waitcnt lgkmcnt(10)
    v_mfma_f32_32x32x16_bf16 v[120:135], v[204:207], v[16:19], v[120:135]
    s_waitcnt lgkmcnt(9)
    v_mfma_f32_32x32x16_bf16 v[104:119], v[208:211], v[20:23], v[104:119]
    s_waitcnt lgkmcnt(8)
    v_mfma_f32_32x32x16_bf16 v[120:135], v[212:215], v[20:23], v[120:135]
    s_waitcnt lgkmcnt(7)
    v_mfma_f32_32x32x16_bf16 v[104:119], v[216:219], v[24:27], v[104:119]
    s_waitcnt lgkmcnt(6)
    v_mfma_f32_32x32x16_bf16 v[120:135], v[220:223], v[24:27], v[120:135]
    s_waitcnt lgkmcnt(5)
    v_mfma_f32_32x32x16_bf16 v[104:119], v[224:227], v[28:31], v[104:119]
    s_waitcnt lgkmcnt(4)
    v_mfma_f32_32x32x16_bf16 v[120:135], v[228:231], v[28:31], v[120:135]
    s_waitcnt lgkmcnt(3)
    v_mfma_f32_32x32x16_bf16 v[104:119], v[184:187], v[32:35], v[104:119]
    s_waitcnt lgkmcnt(2)
    v_mfma_f32_32x32x16_bf16 v[120:135], v[188:191], v[32:35], v[120:135]
    s_waitcnt lgkmcnt(1)
    v_mfma_f32_32x32x16_bf16 v[104:119], v[192:195], v[36:39], v[104:119]
    s_waitcnt lgkmcnt(0)
    v_mfma_f32_32x32x16_bf16 v[120:135], v[196:199], v[36:39], v[120:135]
    s_add_u32 s22, s22, 32768
    s_cmp_ge_u32 s22, 131072
    s_cselect_b32 s22, 0, s22
    s_nop 15
    s_mov_b32 s20, 0
L_loop:
    s_waitcnt vmcnt(4)
    s_barrier
    s_add_u32 m0, s24, s28
    s_nop 0
    buffer_load_dwordx4 v232, s[8:11], s21 offen nt lds
    buffer_load_dwordx4 v233, s[8:11], s21 offen offset:1024 nt lds
    s_add_u32 m0, s24, s29
    s_nop 0
    buffer_load_dwordx4 v234, s[12:15], s21 offen nt lds
    buffer_load_dwordx4 v234, s[12:15], s21 offen offset:1024 nt lds
    s_add_u32 s21, s21, 16384
    s_add_u32 s24, s24, 32768
    s_cmp_ge_u32 s24, 131072
    s_cselect_b32 s24, 0, s24
    v_add_u32 v239, s22, v235
    v_xor_b32 v240, 32, v239
    v_xor_b32 v241, 64, v239
    v_xor_b32 v242, 96, v239
    v_xor_b32 v243, 128, v239
    v_xor_b32 v244, 160, v239
    v_xor_b32 v245, 192, v239
    v_xor_b32 v246, 224, v239
    v_add_u32 v247, s23, v236
    v_xor_b32 v248, 64, v247
    v_xor_b32 v249, 128, v247
    v_xor_b32 v250, 192, v247
    ds_read_b128 v[184:187], v239 offset:0
    ds_read_b128 v[188:191], v239 offset:8192
    ds_read_b128 v[192:195], v240 offset:0
    ds_read_b128 v[196:199], v240 offset:8192
    ds_read_b128 v[200:203], v241 offset:0
    ds_read_b128 v[204:207], v241 offset:8192
    ds_read_b128 v[208:211], v242 offset:0
    ds_read_b128 v[212:215], v242 offset:8192
    ds_read_b128 v[216:219], v243 offset:0
    ds_read_b128 v[220:223], v243 offset:8192
    ds_read_b128 v[224:227], v244 offset:0
    ds_read_b128 v[228:231], v244 offset:8192
    s_waitcnt lgkmcnt(11)
    v_mfma_f32_32x32x16_bf16 v[136:151], v[184:187], v[8:11], 0
    ds_read_b128 v[184:187], v245 offset:0
    v_max3_f32 v5, v104, v105, v106
    v_max3_f32 v6, v107, v108, v109
    v_max3_f32 v5, v110, v111, v5
    v_max3_f32 v6, v112, v113, v6
    v_max3_f32 v5, v114, v115, v5
    v_max3_f32 v6, v116, v117, v6
    v_max3_f32 v5, v118, v119, v5
    s_waitcnt lgkmcnt(11)
    v_mfma_f32_32x32x16_bf16 v[152:167], v[188:191], v[8:11], 0
    ds_read_b128 v[188:191], v245 offset:8192
    v_max3_f32 v6, v120, v121, v6
    v_max3_f32 v5, v122, v123, v5
    v_max3_f32 v6, v124, v125, v6
    v_max3_f32 v5, v126, v127, v5
    v_max3_f32 v6, v128, v129, v6
    v_max3_f32 v5, v130, v131, v5
    v_max3_f32 v6, v132, v133, v6
    s_waitcnt lgkmcnt(11)
    v_mfma_f32_32x32x16_bf16 v[136:151], v[192:195], v[12:15], v[136:151]
    ds_read_b128 v[192:195], v246 offset:0
    v_max3_f32 v5, v134, v135, v5
    v_max_f32 v5, v5, v6
    v_mov_b32 v6, v5
    s_nop 1
    v_permlane32_swap_b32 v5, v6
    v_max_f32 v5, v5, v6
    v_sub_f32 v6, v5, v1
    v_cmp_lt_f32 vcc, s30, v6
    s_nop 4
    s_cbranch_vccnz L_resc0
L_back0:
    s_waitcnt lgkmcnt(11)
    v_mfma_f32_32x32x16_bf16 v[152:167], v[196:199], v[12:15], v[152:167]
    ds_read_b128 v[196:199], v246 offset:8192
    v_fma_f32 v104, v104, s25, -v238
    v_fma_f32 v105, v105, s25, -v238
    v_exp_f32 v104, v104
    s_waitcnt lgkmcnt(11)
    v_mfma_f32_32x32x16_bf16 v[136:151], v[200:203], v[16:19], v[136:151]
    ds_read_b64_tr_b16 v[200:201], v247 offset:16384
    ds_read_b64_tr_b16 v[202:203], v247 offset:18432
    v_fma_f32 v106, v106, s25, -v238
    v_exp_f32 v105, v105
    v_fma_f32 v107, v107, s25, -v238
    v_exp_f32 v106, v106
    s_waitcnt lgkmcnt(12)
    v_mfma_f32_32x32x16_bf16 v[152:167], v[204:207], v[16:19], v[152:167]
    ds_read_b64_tr_b16 v[204:205], v248 offset:16384
    ds_read_b64_tr_b16 v[206:207], v248 offset:18432
    v_fma_f32 v108, v108, s25, -v238
    v_exp_f32 v107, v107
    v_cvt_pk_bf16_f32 v168, v104, v105
    v_fma_f32 v109, v109, s25, -v238
    v_exp_f32 v108, v108
    s_waitcnt lgkmcnt(13)
    v_mfma_f32_32x32x16_bf16 v[136:151], v[208:211], v[20:23], v[136:151]
    ds_read_b64_tr_b16 v[208:209], v249 offset:16384
    ds_read_b64_tr_b16 v[210:211], v249 offset:18432
    v_fma_f32 v110, v110, s25, -v238
    v_exp_f32 v109, v109
    v_cvt_pk_bf16_f32 v169, v106, v107
    v_fma_f32 v111, v111, s25, -v238
    v_exp_f32 v110, v110
    s_waitcnt lgkmcnt(14)
    v_mfma_f32_32x32x16_bf16 v[152:167], v[212:215], v[20:23], v[152:167]
    ds_read_b64_tr_b16 v[212:213], v250 offset:16384
    ds_read_b64_tr_b16 v[214:215], v250 offset:18432
    v_exp_f32 v111, v111
    v_cvt_pk_bf16_f32 v170, v108, v109
    v_add_f32 v2, v2, v104
    v_cvt_pk_bf16_f32 v171, v110, v111
    v_add_f32 v3, v3, v105
    s_waitcnt lgkmcnt(15)
    v_mfma_f32_32x32x16_bf16 v[136:151], v[216:219], v[24:27], v[136:151]
    ds_read_b64_tr_b16 v[216:217], v247 offset:20480
    ds_read_b64_tr_b16 v[218:219], v247 offset:22528
    v_add_f32 v2, v2, v106
    v_add_f32 v3, v3, v107
    v_add_f32 v2, v2, v108
    v_add_f32 v3, v3, v109
    v_add_f32 v2, v2, v110
    v_add_f32 v3, v3, v111
    s_waitcnt lgkmcnt(15)
    v_mfma_f32_32x32x16_bf16 v[152:167], v[220:223], v[24:27], v[152:167]
    ds_read_b64_tr_b16 v[220:221], v248 offset:20480
    ds_read_b64_tr_b16 v[222:223], v248 offset:22528
    v_fma_f32 v112, v112, s25, -v238
    v_fma_f32 v113, v113, s25, -v238
    v_exp_f32 v112, v112
    v_fma_f32 v114, v114, s25, -v238
    v_exp_f32 v113, v113
    s_waitcnt lgkmcnt(15)
    v_mfma_f32_32x32x16_bf16 v[136:151], v[224:227], v[28:31], v[136:151]
    ds_read_b64_tr_b16 v[224:225], v249 offset:20480
    ds_read_b64_tr_b16 v[226:227], v249 offset:22528
    v_fma_f32 v115, v115, s25, -v238
    v_exp_f32 v114, v114
    v_fma_f32 v116, v116, s25, -v238
    v_exp_f32 v115, v115
    s_waitcnt lgkmcnt(15)
    v_mfma_f32_32x32x16_bf16 v[152:167], v[228:231], v[28:31], v[152:167]
    ds_read_b64_tr_b16 v[228:229], v250 offset:20480
    ds_read_b64_tr_b16 v[230:231], v250 offset:22528
    v_cvt_pk_bf16_f32 v172, v112, v113
    v_fma_f32 v117, v117, s25, -v238
    v_exp_f32 v116, v116
    v_fma_f32 v118, v118, s25, -v238
    v_exp_f32 v117, v117
    s_waitcnt lgkmcnt(15)
    v_mfma_f32_32x32x16_bf16 v[136:151], v[184:187], v[32:35], v[136:151]
    ds_read_b64_tr_b16 v[184:185], v247 offset:24576
    ds_read_b64_tr_b16 v[186:187], v247 offset:26624
    v_cvt_pk_bf16_f32 v173, v114, v115
    v_fma_f32 v119, v119, s25, -v238
    v_exp_f32 v118, v118
    v_exp_f32 v119, v119
    s_waitcnt lgkmcnt(15)
    v_mfma_f32_32x32x16_bf16 v[152:167], v[188:191], v[32:35], v[152:167]
    ds_read_b64_tr_b16 v[188:189], v248 offset:24576
    ds_read_b64_tr_b16 v[190:191], v248 offset:26624
    v_cvt_pk_bf16_f32 v174, v116, v117
    v_add_f32 v2, v2, v112
    v_cvt_pk_bf16_f32 v175, v118, v119
    v_add_f32 v3, v3, v113
    v_add_f32 v2, v2, v114
    v_add_f32 v3, v3, v115
    v_add_f32 v2, v2, v116
    s_waitcnt lgkmcnt(15)
    v_mfma_f32_32x32x16_bf16 v[136:151], v[192:195], v[36:39], v[136:151]
    ds_read_b64_tr_b16 v[192:193], v249 offset:24576
    ds_read_b64_tr_b16 v[194:195], v249 offset:26624
    v_add_f32 v3, v3, v117
    v_add_f32 v2, v2, v118
    v_add_f32 v3, v3, v119
    v_fma_f32 v120, v120, s25, -v238
    v_fma_f32 v121, v121, s25, -v238
    v_exp_f32 v120, v120
    s_waitcnt lgkmcnt(15)
    v_mfma_f32_32x32x16_bf16 v[152:167], v[196:199], v[36:39], v[152:167]
    ds_read_b64_tr_b16 v[196:197], v250 offset:24576
    ds_read_b64_tr_b16 v[198:199], v250 offset:26624
    v_fma_f32 v122, v122, s25, -v238
    v_exp_f32 v121, v121
    v_fma_f32 v123, v123, s25, -v238
    v_exp_f32 v122, v122
    s_waitcnt lgkmcnt(15)
    v_mfma_f32_32x32x16_bf16 v[40:55], v[200:203], v[168:171], v[40:55]
    ds_read_b64_tr_b16 v[200:201], v247 offset:28672
    ds_read_b64_tr_b16 v[202:203], v247 offset:30720
    v_fma_f32 v124, v124, s25, -v238
    v_exp_f32 v123, v123
    v_cvt_pk_bf16_f32 v176, v120, v121
    v_fma_f32 v125, v125, s25, -v238
    v_exp_f32 v124, v124
    s_waitcnt lgkmcnt(15)
    v_mfma_f32_32x32x16_bf16 v[56:71], v[204:207], v[168:171], v[56:71]
    ds_read_b64_tr_b16 v[204:205], v248 offset:28672
    ds_read_b64_tr_b16 v[206:207], v248 offset:30720
    v_fma_f32 v126, v126, s25, -v238
    v_exp_f32 v125, v125
    v_cvt_pk_bf16_f32 v177, v122, v123
    v_fma_f32 v127, v127, s25, -v238
    v_exp_f32 v126, v126
    s_waitcnt lgkmcnt(15)
    v_mfma_f32_32x32x16_bf16 v[72:87], v[208:211], v[168:171], v[72:87]
    ds_read_b64_tr_b16 v[208:209], v249 offset:28672
    ds_read_b64_tr_b16 v[210:211], v249 offset:30720
    v_exp_f32 v127, v127
    v_cvt_pk_bf16_f32 v178, v124, v125
    v_add_f32 v2, v2, v120
    v_cvt_pk_bf16_f32 v179, v126, v127
    s_waitcnt lgkmcnt(15)
    v_mfma_f32_32x32x16_bf16 v[88:103], v[212:215], v[168:171], v[88:103]
    ds_read_b64_tr_b16 v[212:213], v250 offset:28672
    ds_read_b64_tr_b16 v[214:215], v250 offset:30720
    v_add_f32 v3, v3, v121
    v_add_f32 v2, v2, v122
    v_add_f32 v3, v3, v123
    v_add_f32 v2, v2, v124
    v_add_f32 v3, v3, v125
    v_add_f32 v2, v2, v126
    v_add_f32 v3, v3, v127
    s_waitcnt lgkmcnt(15)
    v_mfma_f32_32x32x16_bf16 v[40:55], v[216:219], v[172:175], v[40:55]
    v_fma_f32 v128, v128, s25, -v238
    v_fma_f32 v129, v129, s25, -v238
    v_exp_f32 v128, v128
    v_fma_f32 v130, v130, s25, -v238
    v_exp_f32 v129, v129
    s_waitcnt lgkmcnt(15)
    v_mfma_f32_32x32x16_bf16 v[56:71], v[220:223], v[172:175], v[56:71]
    v_fma_f32 v131, v131, s25, -v238
    v_exp_f32 v130, v130
    v_fma_f32 v132, v132, s25, -v238
    v_exp_f32 v131, v131
    s_waitcnt lgkmcnt(15)
    v_mfma_f32_32x32x16_bf16 v[72:87], v[224:227], v[172:175], v[72:87]
    v_cvt_pk_bf16_f32 v180, v128, v129
    v_fma_f32 v133, v133, s25, -v238
    v_exp_f32 v132, v132
    v_fma_f32 v134, v134, s25, -v238
    v_exp_f32 v133, v133
    s_waitcnt lgkmcnt(15)
    v_mfma_f32_32x32x16_bf16 v[88:103], v[228:231], v[172:175], v[88:103]
    v_cvt_pk_bf16_f32 v181, v130, v131
    v_fma_f32 v135, v135, s25, -v238
    v_exp_f32 v134, v134
    v_exp_f32 v135, v135
    s_waitcnt lgkmcnt(14)
    v_mfma_f32_32x32x16_bf16 v[40:55], v[184:187], v[176:179], v[40:55]
    v_cvt_pk_bf16_f32 v182, v132, v133
    v_add_f32 v2, v2, v128
    v_cvt_pk_bf16_f32 v183, v134, v135
    v_add_f32 v3, v3, v129
    v_add_f32 v2, v2, v130
    v_add_f32 v3, v3, v131
    v_add_f32 v2, v2, v132
    s_waitcnt lgkmcnt(12)
    v_mfma_f32_32x32x16_bf16 v[56:71], v[188:191], v[176:179], v[56:71]
    v_add_f32 v3, v3, v133
    v_add_f32 v2, v2, v134
    v_add_f32 v3, v3, v135
    s_waitcnt lgkmcnt(10)
    v_mfma_f32_32x32x16_bf16 v[72:87], v[192:195], v[176:179], v[72:87]
    s_waitcnt lgkmcnt(8)
    v_mfma_f32_32x32x16_bf16 v[88:103], v[196:199], v[176:179], v[88:103]
    s_waitcnt lgkmcnt(6)
    v_mfma_f32_32x32x16_bf16 v[40:55], v[200:203], v[180:183], v[40:55]
    s_waitcnt lgkmcnt(4)
    v_mfma_f32_32x32x16_bf16 v[56:71], v[204:207], v[180:183], v[56:71]
    s_waitcnt lgkmcnt(2)
    v_mfma_f32_32x32x16_bf16 v[72:87], v[208:211], v[180:183], v[72:87]
    s_waitcnt lgkmcnt(0)
    v_mfma_f32_32x32x16_bf16 v[88:103], v[212:215], v[180:183], v[88:103]
    s_add_u32 s22, s22, 32768
    s_cmp_ge_u32 s22, 131072
    s_cselect_b32 s22, 0, s22
    s_add_u32 s23, s23, 32768
    s_cmp_ge_u32 s23, 131072
    s_cselect_b32 s23, 0, s23
    s_waitcnt vmcnt(4)
    s_barrier
    s_add_u32 m0, s24, s28
    s_nop 0
    buffer_load_dwordx4 v232, s[8:11], s21 offen nt lds
    buffer_load_dwordx4 v233, s[8:11], s21 offen offset:1024 nt lds
    s_add_u32 m0, s24, s29
    s_nop 0
    buffer_load_dwordx4 v234, s[12:15], s21 offen nt lds
    buffer_load_dwordx4 v234, s[12:15], s21 offen offset:1024 nt lds
    s_add_u32 s21, s21, 16384
    s_add_u32 s24, s24, 32768
    s_cmp_ge_u32 s24, 131072
    s_cselect_b32 s24, 0, s24
    v_add_u32 v239, s22, v235
    v_xor_b32 v240, 32, v239
    v_xor_b32 v241, 64, v239
    v_xor_b32 v242, 96, v239
    v_xor_b32 v243, 128, v239
    v_xor_b32 v244, 160, v239
    v_xor_b32 v245, 192, v239
    v_xor_b32 v246, 224, v239
    v_add_u32 v247, s23, v236
    v_xor_b32 v248, 64, v247
    v_xor_b32 v249, 128, v247
    v_xor_b32 v250, 192, v247
    ds_read_b128 v[184:187], v239 offset:0
    ds_read_b128 v[188:191], v239 offset:8192
    ds_read_b128 v[192:195], v240 offset:0
    ds_read_b128 v[196:199], v240 offset:8192
    ds_read_b128 v[200:203], v241 offset:0
    ds_read_b128 v[204:207], v241 offset:8192
    ds_read_b128 v[208:211], v242 offset:0
    ds_read_b128 v[212:215], v242 offset:8192
    ds_read_b128 v[216:219], v243 offset:0
    ds_read_b128 v[220:223], v243 offset:8192
    ds_read_b128 v[224:227], v244 offset:0
    ds_read_b128 v[228:231], v244 offset:8192
    s_waitcnt lgkmcnt(11)
    v_mfma_f32_32x32x16_bf16 v[104:119], v[184:187], v[8:11], 0
    ds_read_b128 v[184:187], v245 offset:0
    v_max3_f32 v5, v136, v137, v138
    v_max3_f32 v6, v139, v140, v141
    v_max3_f32 v5, v142, v143, v5
    v_max3_f32 v6, v144, v145, v6
    v_max3_f32 v5, v146, v147, v5
    v_max3_f32 v6, v148, v149, v6
    v_max3_f32 v5, v150, v151, v5
    s_waitcnt lgkmcnt(11)
    v_mfma_f32_32x32x16_bf16 v[120:135], v[188:191], v[8:11], 0
    ds_read_b128 v[188:191], v245 offset:8192
    v_max3_f32 v6, v152, v153, v6
    v_max3_f32 v5, v154, v155, v5
    v_max3_f32 v6, v156, v157, v6
    v_max3_f32 v5, v158, v159, v5
    v_max3_f32 v6, v160, v161, v6
    v_max3_f32 v5, v162, v163, v5
    v_max3_f32 v6, v164, v165, v6
    s_waitcnt lgkmcnt(11)
    v_mfma_f32_32x32x16_bf16 v[104:119], v[192:195], v[12:15], v[104:119]
    ds_read_b128 v[192:195], v246 offset:0
    v_max3_f32 v5, v166, v167, v5
    v_max_f32 v5, v5, v6
    v_mov_b32 v6, v5
    s_nop 1
    v_permlane32_swap_b32 v5, v6
    v_max_f32 v5, v5, v6
    v_sub_f32 v6, v5, v1
    v_cmp_lt_f32 vcc, s30, v6
    s_nop 4
    s_cbranch_vccnz L_resc1
L_back1:
    s_waitcnt lgkmcnt(11)
    v_mfma_f32_32x32x16_bf16 v[120:135], v[196:199], v[12:15], v[120:135]
    ds_read_b128 v[196:199], v246 offset:8192
    v_fma_f32 v136, v136, s25, -v238
    v_fma_f32 v137, v137, s25, -v238
    v_exp_f32 v136, v136
    s_waitcnt lgkmcnt(11)
    v_mfma_f32_32x32x16_bf16 v[104:119], v[200:203], v[16:19], v[104:119]
    ds_read_b64_tr_b16 v[200:201], v247 offset:16384
    ds_read_b64_tr_b16 v[202:203], v247 offset:18432
    v_fma_f32 v138, v138, s25, -v238
    v_exp_f32 v137, v137
    v_fma_f32 v139, v139, s25, -v238
    v_exp_f32 v138, v138
    s_waitcnt lgkmcnt(12)
    v_mfma_f32_32x32x16_bf16 v[120:135], v[204:207], v[16:19], v[120:135]
    ds_read_b64_tr_b16 v[204:205], v248 offset:16384
    ds_read_b64_tr_b16 v[206:207], v248 offset:18432
    v_fma_f32 v140, v140, s25, -v238
    v_exp_f32 v139, v139
    v_cvt_pk_bf16_f32 v168, v136, v137
    v_fma_f32 v141, v141, s25, -v238
    v_exp_f32 v140, v140
    s_waitcnt lgkmcnt(13)
    v_mfma_f32_32x32x16_bf16 v[104:119], v[208:211], v[20:23], v[104:119]
    ds_read_b64_tr_b16 v[208:209], v249 offset:16384
    ds_read_b64_tr_b16 v[210:211], v249 offset:18432
    v_fma_f32 v142, v142, s25, -v238
    v_exp_f32 v141, v141
    v_cvt_pk_bf16_f32 v169, v138, v139
    v_fma_f32 v143, v143, s25, -v238
    v_exp_f32 v142, v142
    s_waitcnt lgkmcnt(14)
    v_mfma_f32_32x32x16_bf16 v[120:135], v[212:215], v[20:23], v[120:135]
    ds_read_b64_tr_b16 v[212:213], v250 offset:16384
    ds_read_b64_tr_b16 v[214:215], v250 offset:18432
    v_exp_f32 v143, v143
    v_cvt_pk_bf16_f32 v170, v140, v141
    v_add_f32 v2, v2, v136
    v_cvt_pk_bf16_f32 v171, v142, v143
    v_add_f32 v3, v3, v137
    s_waitcnt lgkmcnt(15)
    v_mfma_f32_32x32x16_bf16 v[104:119], v[216:219], v[24:27], v[104:119]
    ds_read_b64_tr_b16 v[216:217], v247 offset:20480
    ds_read_b64_tr_b16 v[218:219], v247 offset:22528
    v_add_f32 v2, v2, v138
    v_add_f32 v3, v3, v139
    v_add_f32 v2, v2, v140
    v_add_f32 v3, v3, v141
    v_add_f32 v2, v2, v142
    v_add_f32 v3, v3, v143
    s_waitcnt lgkmcnt(15)
    v_mfma_f32_32x32x16_bf16 v[120:135], v[220:223], v[24:27], v[120:135]
    ds_read_b64_tr_b16 v[220:221], v248 offset:20480
    ds_read_b64_tr_b16 v[222:223], v248 offset:22528
    v_fma_f32 v144, v144, s25, -v238
    v_fma_f32 v145, v145, s25, -v238
    v_exp_f32 v144, v144
    v_fma_f32 v146, v146, s25, -v238
    v_exp_f32 v145, v145
    s_waitcnt lgkmcnt(15)
    v_mfma_f32_32x32x16_bf16 v[104:119], v[224:227], v[28:31], v[104:119]
    ds_read_b64_tr_b16 v[224:225], v249 offset:20480
    ds_read_b64_tr_b16 v[226:227], v249 offset:22528
    v_fma_f32 v147, v147, s25, -v238
    v_exp_f32 v146, v146
    v_fma_f32 v148, v148, s25, -v238
    v_exp_f32 v147, v147
    s_waitcnt lgkmcnt(15)
    v_mfma_f32_32x32x16_bf16 v[120:135], v[228:231], v[28:31], v[120:135]
    ds_read_b64_tr_b16 v[228:229], v250 offset:20480
    ds_read_b64_tr_b16 v[230:231], v250 offset:22528
    v_cvt_pk_bf16_f32 v172, v144, v145
    v_fma_f32 v149, v149, s25, -v238
    v_exp_f32 v148, v148
    v_fma_f32 v150, v150, s25, -v238
    v_exp_f32 v149, v149
    s_waitcnt lgkmcnt(15)
    v_mfma_f32_32x32x16_bf16 v[104:119], v[184:187], v[32:35], v[104:119]
    ds_read_b64_tr_b16 v[184:185], v247 offset:24576
    ds_read_b64_tr_b16 v[186:187], v247 offset:26624
    v_cvt_pk_bf16_f32 v173, v146, v147
    v_fma_f32 v151, v151, s25, -v238
    v_exp_f32 v150, v150
    v_exp_f32 v151, v151
    s_waitcnt lgkmcnt(15)
    v_mfma_f32_32x32x16_bf16 v[120:135], v[188:191], v[32:35], v[120:135]
    ds_read_b64_tr_b16 v[188:189], v248 offset:24576
    ds_read_b64_tr_b16 v[190:191], v248 offset:26624
    v_cvt_pk_bf16_f32 v174, v148, v149
    v_add_f32 v2, v2, v144
    v_cvt_pk_bf16_f32 v175, v150, v151
    v_add_f32 v3, v3, v145
    v_add_f32 v2, v2, v146
    v_add_f32 v3, v3, v147
    v_add_f32 v2, v2, v148
    s_waitcnt lgkmcnt(15)
    v_mfma_f32_32x32x16_bf16 v[104:119], v[192:195], v[36:39], v[104:119]
    ds_read_b64_tr_b16 v[192:193], v249 offset:24576
    ds_read_b64_tr_b16 v[194:195], v249 offset:26624
    v_add_f32 v3, v3, v149
    v_add_f32 v2, v2, v150
    v_add_f32 v3, v3, v151
    v_fma_f32 v152, v152, s25, -v238
    v_fma_f32 v153, v153, s25, -v238
    v_exp_f32 v152, v152
    s_waitcnt lgkmcnt(15)
    v_mfma_f32_32x32x16_bf16 v[120:135], v[196:199], v[36:39], v[120:135]
    ds_read_b64_tr_b16 v[196:197], v250 offset:24576
    ds_read_b64_tr_b16 v[198:199], v250 offset:26624
    v_fma_f32 v154, v154, s25, -v238
    v_exp_f32 v153, v153
    v_fma_f32 v155, v155, s25, -v238
    v_exp_f32 v154, v154
    s_waitcnt lgkmcnt(15)
    v_mfma_f32_32x32x16_bf16 v[40:55], v[200:203], v[168:171], v[40:55]
    ds_read_b64_tr_b16 v[200:201], v247 offset:28672
    ds_read_b64_tr_b16 v[202:203], v247 offset:30720
    v_fma_f32 v156, v156, s25, -v238
    v_exp_f32 v155, v155
    v_cvt_pk_bf16_f32 v176, v152, v153
    v_fma_f32 v157, v157, s25, -v238
    v_exp_f32 v156, v156
    s_waitcnt lgkmcnt(15)
    v_mfma_f32_32x32x16_bf16 v[56:71], v[204:207], v[168:171], v[56:71]
    ds_read_b64_tr_b16 v[204:205], v248 offset:28672
    ds_read_b64_tr_b16 v[206:207], v248 offset:30720
    v_fma_f32 v158, v158, s25, -v238
    v_exp_f32 v157, v157
    v_cvt_pk_bf16_f32 v177, v154, v155
    v_fma_f32 v159, v159, s25, -v238
    v_exp_f32 v158, v158
    s_waitcnt lgkmcnt(15)
    v_mfma_f32_32x32x16_bf16 v[72:87], v[208:211], v[168:171], v[72:87]
    ds_read_b64_tr_b16 v[208:209], v249 offset:28672
    ds_read_b64_tr_b16 v[210:211], v249 offset:30720
    v_exp_f32 v159, v159
    v_cvt_pk_bf16_f32 v178, v156, v157
    v_add_f32 v2, v2, v152
    v_cvt_pk_bf16_f32 v179, v158, v159
    s_waitcnt lgkmcnt(15)
    v_mfma_f32_32x32x16_bf16 v[88:103], v[212:215], v[168:171], v[88:103]
    ds_read_b64_tr_b16 v[212:213], v250 offset:28672
    ds_read_b64_tr_b16 v[214:215], v250 offset:30720
    v_add_f32 v3, v3, v153
    v_add_f32 v2, v2, v154
    v_add_f32 v3, v3, v155
    v_add_f32 v2, v2, v156
    v_add_f32 v3, v3, v157
    v_add_f32 v2, v2, v158
    v_add_f32 v3, v3, v159
    s_waitcnt lgkmcnt(15)
    v_mfma_f32_32x32x16_bf16 v[40:55], v[216:219], v[172:175], v[40:55]
    v_fma_f32 v160, v160, s25, -v238
    v_fma_f32 v161, v161, s25, -v238
    v_exp_f32 v160, v160
    v_fma_f32 v162, v162, s25, -v238
    v_exp_f32 v161, v161
    s_waitcnt lgkmcnt(15)
    v_mfma_f32_32x32x16_bf16 v[56:71], v[220:223], v[172:175], v[56:71]
    v_fma_f32 v163, v163, s25, -v238
    v_exp_f32 v162, v162
    v_fma_f32 v164, v164, s25, -v238
    v_exp_f32 v163, v163
    s_waitcnt lgkmcnt(15)
    v_mfma_f32_32x32x16_bf16 v[72:87], v[224:227], v[172:175], v[72:87]
    v_cvt_pk_bf16_f32 v180, v160, v161
    v_fma_f32 v165, v165, s25, -v238
    v_exp_f32 v164, v164
    v_fma_f32 v166, v166, s25, -v238
    v_exp_f32 v165, v165
    s_waitcnt lgkmcnt(15)
    v_mfma_f32_32x32x16_bf16 v[88:103], v[228:231], v[172:175], v[88:103]
    v_cvt_pk_bf16_f32 v181, v162, v163
    v_fma_f32 v167, v167, s25, -v238
    v_exp_f32 v166, v166
    v_exp_f32 v167, v167
    s_waitcnt lgkmcnt(14)
    v_mfma_f32_32x32x16_bf16 v[40:55], v[184:187], v[176:179], v[40:55]
    v_cvt_pk_bf16_f32 v182, v164, v165
    v_add_f32 v2, v2, v160
    v_cvt_pk_bf16_f32 v183, v166, v167
    v_add_f32 v3, v3, v161
    v_add_f32 v2, v2, v162
    v_add_f32 v3, v3, v163
    v_add_f32 v2, v2, v164
    s_waitcnt lgkmcnt(12)
    v_mfma_f32_32x32x16_bf16 v[56:71], v[188:191], v[176:179], v[56:71]
    v_add_f32 v3, v3, v165
    v_add_f32 v2, v2, v166
    v_add_f32 v3, v3, v167
    s_waitcnt lgkmcnt(10)
    v_mfma_f32_32x32x16_bf16 v[72:87], v[192:195], v[176:179], v[72:87]
    s_waitcnt lgkmcnt(8)
    v_mfma_f32_32x32x16_bf16 v[88:103], v[196:199], v[176:179], v[88:103]
    s_waitcnt lgkmcnt(6)
    v_mfma_f32_32x32x16_bf16 v[40:55], v[200:203], v[180:183], v[40:55]
    s_waitcnt lgkmcnt(4)
    v_mfma_f32_32x32x16_bf16 v[56:71], v[204:207], v[180:183], v[56:71]
    s_waitcnt lgkmcnt(2)
    v_mfma_f32_32x32x16_bf16 v[72:87], v[208:211], v[180:183], v[72:87]
    s_waitcnt lgkmcnt(0)
    v_mfma_f32_32x32x16_bf16 v[88:103], v[212:215], v[180:183], v[88:103]
    s_add_u32 s22, s22, 32768
    s_cmp_ge_u32 s22, 131072
    s_cselect_b32 s22, 0, s22
    s_add_u32 s23, s23, 32768
    s_cmp_ge_u32 s23, 131072
    s_cselect_b32 s23, 0, s23
    s_add_u32 s20, s20, 2
    s_cmp_lt_u32 s20, 12
    s_cbranch_scc1 L_loop
    s_waitcnt vmcnt(4)
    s_barrier
    s_add_u32 m0, s24, s28
    s_nop 0
    buffer_load_dwordx4 v232, s[8:11], s21 offen nt lds
    buffer_load_dwordx4 v233, s[8:11], s21 offen offset:1024 nt lds
    s_add_u32 m0, s24, s29
    s_nop 0
    buffer_load_dwordx4 v234, s[12:15], s21 offen nt lds
    buffer_load_dwordx4 v234, s[12:15], s21 offen offset:1024 nt lds
    s_add_u32 s21, s21, 16384
    s_add_u32 s24, s24, 32768
    s_cmp_ge_u32 s24, 131072
    s_cselect_b32 s24, 0, s24
    v_add_u32 v239, s22, v235
    v_xor_b32 v240, 32, v239
    v_xor_b32 v241, 64, v239
    v_xor_b32 v242, 96, v239
    v_xor_b32 v243, 128, v239
    v_xor_b32 v244, 160, v239
    v_xor_b32 v245, 192, v239
    v_xor_b32 v246, 224, v239
    v_add_u32 v247, s23, v236
    v_xor_b32 v248, 64, v247
    v_xor_b32 v249, 128, v247
    v_xor_b32 v250, 192, v247
    ds_read_b128 v[184:187], v239 offset:0
    ds_read_b128 v[188:191], v239 offset:8192
    ds_read_b128 v[192:195], v240 offset:0
    ds_read_b128 v[196:199], v240 offset:8192
    ds_read_b128 v[200:203], v241 offset:0
    ds_read_b128 v[204:207], v241 offset:8192
    ds_read_b128 v[208:211], v242 offset:0
    ds_read_b128 v[212:215], v242 offset:8192
    ds_read_b128 v[216:219], v243 offset:0
    ds_read_b128 v[220:223], v243 offset:8192
    ds_read_b128 v[224:227], v244 offset:0
    ds_read_b128 v[228:231], v244 offset:8192
    s_waitcnt lgkmcnt(11)
    v_mfma_f32_32x32x16_bf16 v[136:151], v[184:187], v[8:11], 0
    ds_read_b128 v[184:187], v245 offset:0
    v_max3_f32 v5, v104, v105, v106
    v_max3_f32 v6, v107, v108, v109
    v_max3_f32 v5, v110, v111, v5
    v_max3_f32 v6, v112, v113, v6
    v_max3_f32 v5, v114, v115, v5
    v_max3_f32 v6, v116, v117, v6
    v_max3_f32 v5, v118, v119, v5
    s_waitcnt lgkmcnt(11)
    v_mfma_f32_32x32x16_bf16 v[152:167], v[188:191], v[8:11], 0
    ds_read_b128 v[188:191], v245 offset:8192
    v_max3_f32 v6, v120, v121, v6
    v_max3_f32 v5, v122, v123, v5
    v_max3_f32 v6, v124, v125, v6
    v_max3_f32 v5, v126, v127, v5
    v_max3_f32 v6, v128, v129, v6
    v_max3_f32 v5, v130, v131, v5
    v_max3_f32 v6, v132, v133, v6
    s_waitcnt lgkmcnt(11)
    v_mfma_f32_32x32x16_bf16 v[136:151], v[192:195], v[12:15], v[136:151]
    ds_read_b128 v[192:195], v246 offset:0
    v_max3_f32 v5, v134, v135, v5
    v_max_f32 v5, v5, v6
    v_mov_b32 v6, v5
    s_nop 1
    v_permlane32_swap_b32 v5, v6
    v_max_f32 v5, v5, v6
    v_sub_f32 v6, v5, v1
    v_cmp_lt_f32 vcc, s30, v6
    s_nop 4
    s_cbranch_vccnz L_resc2
L_back2:
    s_waitcnt lgkmcnt(11)
    v_mfma_f32_32x32x16_bf16 v[152:167], v[196:199], v[12:15], v[152:167]
    ds_read_b128 v[196:199], v246 offset:8192
    v_fma_f32 v104, v104, s25, -v238
    v_fma_f32 v105, v105, s25, -v238
    v_exp_f32 v104, v104
    s_waitcnt lgkmcnt(11)
    v_mfma_f32_32x32x16_bf16 v[136:151], v[200:203], v[16:19], v[136:151]
    ds_read_b64_tr_b16 v[200:201], v247 offset:16384
    ds_read_b64_tr_b16 v[202:203], v247 offset:18432
    v_fma_f32 v106, v106, s25, -v238
    v_exp_f32 v105, v105
    v_fma_f32 v107, v107, s25, -v238
    v_exp_f32 v106, v106
    s_waitcnt lgkmcnt(12)
    v_mfma_f32_32x32x16_bf16 v[152:167], v[204:207], v[16:19], v[152:167]
    ds_read_b64_tr_b16 v[204:205], v248 offset:16384
    ds_read_b64_tr_b16 v[206:207], v248 offset:18432
    v_fma_f32 v108, v108, s25, -v238
    v_exp_f32 v107, v107
    v_cvt_pk_bf16_f32 v168, v104, v105
    v_fma_f32 v109, v109, s25, -v238
    v_exp_f32 v108, v108
    s_waitcnt lgkmcnt(13)
    v_mfma_f32_32x32x16_bf16 v[136:151], v[208:211], v[20:23], v[136:151]
    ds_read_b64_tr_b16 v[208:209], v249 offset:16384
    ds_read_b64_tr_b16 v[210:211], v249 offset:18432
    v_fma_f32 v110, v110, s25, -v238
    v_exp_f32 v109, v109
    v_cvt_pk_bf16_f32 v169, v106, v107
    v_fma_f32 v111, v111, s25, -v238
    v_exp_f32 v110, v110
    s_waitcnt lgkmcnt(14)
    v_mfma_f32_32x32x16_bf16 v[152:167], v[212:215], v[20:23], v[152:167]
    ds_read_b64_tr_b16 v[212:213], v250 offset:16384
    ds_read_b64_tr_b16 v[214:215], v250 offset:18432
    v_exp_f32 v111, v111
    v_cvt_pk_bf16_f32 v170, v108, v109
    v_add_f32 v2, v2, v104
    v_cvt_pk_bf16_f32 v171, v110, v111
    v_add_f32 v3, v3, v105
    s_waitcnt lgkmcnt(15)
    v_mfma_f32_32x32x16_bf16 v[136:151], v[216:219], v[24:27], v[136:151]
    ds_read_b64_tr_b16 v[216:217], v247 offset:20480
    ds_read_b64_tr_b16 v[218:219], v247 offset:22528
    v_add_f32 v2, v2, v106
    v_add_f32 v3, v3, v107
    v_add_f32 v2, v2, v108
    v_add_f32 v3, v3, v109
    v_add_f32 v2, v2, v110
    v_add_f32 v3, v3, v111
    s_waitcnt lgkmcnt(15)
    v_mfma_f32_32x32x16_bf16 v[152:167], v[220:223], v[24:27], v[152:167]
    ds_read_b64_tr_b16 v[220:221], v248 offset:20480
    ds_read_b64_tr_b16 v[222:223], v248 offset:22528
    v_fma_f32 v112, v112, s25, -v238
    v_fma_f32 v113, v113, s25, -v238
    v_exp_f32 v112, v112
    v_fma_f32 v114, v114, s25, -v238
    v_exp_f32 v113, v113
    s_waitcnt lgkmcnt(15)
    v_mfma_f32_32x32x16_bf16 v[136:151], v[224:227], v[28:31], v[136:151]
    ds_read_b64_tr_b16 v[224:225], v249 offset:20480
    ds_read_b64_tr_b16 v[226:227], v249 offset:22528
    v_fma_f32 v115, v115, s25, -v238
    v_exp_f32 v114, v114
    v_fma_f32 v116, v116, s25, -v238
    v_exp_f32 v115, v115
    s_waitcnt lgkmcnt(15)
    v_mfma_f32_32x32x16_bf16 v[152:167], v[228:231], v[28:31], v[152:167]
    ds_read_b64_tr_b16 v[228:229], v250 offset:20480
    ds_read_b64_tr_b16 v[230:231], v250 offset:22528
    v_cvt_pk_bf16_f32 v172, v112, v113
    v_fma_f32 v117, v117, s25, -v238
    v_exp_f32 v116, v116
    v_fma_f32 v118, v118, s25, -v238
    v_exp_f32 v117, v117
    s_waitcnt lgkmcnt(15)
    v_mfma_f32_32x32x16_bf16 v[136:151], v[184:187], v[32:35], v[136:151]
    ds_read_b64_tr_b16 v[184:185], v247 offset:24576
    ds_read_b64_tr_b16 v[186:187], v247 offset:26624
    v_cvt_pk_bf16_f32 v173, v114, v115
    v_fma_f32 v119, v119, s25, -v238
    v_exp_f32 v118, v118
    v_exp_f32 v119, v119
    s_waitcnt lgkmcnt(15)
    v_mfma_f32_32x32x16_bf16 v[152:167], v[188:191], v[32:35], v[152:167]
    ds_read_b64_tr_b16 v[188:189], v248 offset:24576
    ds_read_b64_tr_b16 v[190:191], v248 offset:26624
    v_cvt_pk_bf16_f32 v174, v116, v117
    v_add_f32 v2, v2, v112
    v_cvt_pk_bf16_f32 v175, v118, v119
    v_add_f32 v3, v3, v113
    v_add_f32 v2, v2, v114
    v_add_f32 v3, v3, v115
    v_add_f32 v2, v2, v116
    s_waitcnt lgkmcnt(15)
    v_mfma_f32_32x32x16_bf16 v[136:151], v[192:195], v[36:39], v[136:151]
    ds_read_b64_tr_b16 v[192:193], v249 offset:24576
    ds_read_b64_tr_b16 v[194:195], v249 offset:26624
    v_add_f32 v3, v3, v117
    v_add_f32 v2, v2, v118
    v_add_f32 v3, v3, v119
    v_fma_f32 v120, v120, s25, -v238
    v_fma_f32 v121, v121, s25, -v238
    v_exp_f32 v120, v120
    s_waitcnt lgkmcnt(15)
    v_mfma_f32_32x32x16_bf16 v[152:167], v[196:199], v[36:39], v[152:167]
    ds_read_b64_tr_b16 v[196:197], v250 offset:24576
    ds_read_b64_tr_b16 v[198:199], v250 offset:26624
    v_fma_f32 v122, v122, s25, -v238
    v_exp_f32 v121, v121
    v_fma_f32 v123, v123, s25, -v238
    v_exp_f32 v122, v122
    s_waitcnt lgkmcnt(15)
    v_mfma_f32_32x32x16_bf16 v[40:55], v[200:203], v[168:171], v[40:55]
    ds_read_b64_tr_b16 v[200:201], v247 offset:28672
    ds_read_b64_tr_b16 v[202:203], v247 offset:30720
    v_fma_f32 v124, v124, s25, -v238
    v_exp_f32 v123, v123
    v_cvt_pk_bf16_f32 v176, v120, v121
    v_fma_f32 v125, v125, s25, -v238
    v_exp_f32 v124, v124
    s_waitcnt lgkmcnt(15)
    v_mfma_f32_32x32x16_bf16 v[56:71], v[204:207], v[168:171], v[56:71]
    ds_read_b64_tr_b16 v[204:205], v248 offset:28672
    ds_read_b64_tr_b16 v[206:207], v248 offset:30720
    v_fma_f32 v126, v126, s25, -v238
    v_exp_f32 v125, v125
    v_cvt_pk_bf16_f32 v177, v122, v123
    v_fma_f32 v127, v127, s25, -v238
    v_exp_f32 v126, v126
    s_waitcnt lgkmcnt(15)
    v_mfma_f32_32x32x16_bf16 v[72:87], v[208:211], v[168:171], v[72:87]
    ds_read_b64_tr_b16 v[208:209], v249 offset:28672
    ds_read_b64_tr_b16 v[210:211], v249 offset:30720
    v_exp_f32 v127, v127
    v_cvt_pk_bf16_f32 v178, v124, v125
    v_add_f32 v2, v2, v120
    v_cvt_pk_bf16_f32 v179, v126, v127
    s_waitcnt lgkmcnt(15)
    v_mfma_f32_32x32x16_bf16 v[88:103], v[212:215], v[168:171], v[88:103]
    ds_read_b64_tr_b16 v[212:213], v250 offset:28672
    ds_read_b64_tr_b16 v[214:215], v250 offset:30720
    v_add_f32 v3, v3, v121
    v_add_f32 v2, v2, v122
    v_add_f32 v3, v3, v123
    v_add_f32 v2, v2, v124
    v_add_f32 v3, v3, v125
    v_add_f32 v2, v2, v126
    v_add_f32 v3, v3, v127
    s_waitcnt lgkmcnt(15)
    v_mfma_f32_32x32x16_bf16 v[40:55], v[216:219], v[172:175], v[40:55]
    v_fma_f32 v128, v128, s25, -v238
    v_fma_f32 v129, v129, s25, -v238
    v_exp_f32 v128, v128
    v_fma_f32 v130, v130, s25, -v238
    v_exp_f32 v129, v129
    s_waitcnt lgkmcnt(15)
    v_mfma_f32_32x32x16_bf16 v[56:71], v[220:223], v[172:175], v[56:71]
    v_fma_f32 v131, v131, s25, -v238
    v_exp_f32 v130, v130
    v_fma_f32 v132, v132, s25, -v238
    v_exp_f32 v131, v131
    s_waitcnt lgkmcnt(15)
    v_mfma_f32_32x32x16_bf16 v[72:87], v[224:227], v[172:175], v[72:87]
    v_cvt_pk_bf16_f32 v180, v128, v129
    v_fma_f32 v133, v133, s25, -v238
    v_exp_f32 v132, v132
    v_fma_f32 v134, v134, s25, -v238
    v_exp_f32 v133, v133
    s_waitcnt lgkmcnt(15)
    v_mfma_f32_32x32x16_bf16 v[88:103], v[228:231], v[172:175], v[88:103]
    v_cvt_pk_bf16_f32 v181, v130, v131
    v_fma_f32 v135, v135, s25, -v238
    v_exp_f32 v134, v134
    v_exp_f32 v135, v135
    s_waitcnt lgkmcnt(14)
    v_mfma_f32_32x32x16_bf16 v[40:55], v[184:187], v[176:179], v[40:55]
    v_cvt_pk_bf16_f32 v182, v132, v133
    v_add_f32 v2, v2, v128
    v_cvt_pk_bf16_f32 v183, v134, v135
    v_add_f32 v3, v3, v129
    v_add_f32 v2, v2, v130
    v_add_f32 v3, v3, v131
    v_add_f32 v2, v2, v132
    s_waitcnt lgkmcnt(12)
    v_mfma_f32_32x32x16_bf16 v[56:71], v[188:191], v[176:179], v[56:71]
    v_add_f32 v3, v3, v133
    v_add_f32 v2, v2, v134
    v_add_f32 v3, v3, v135
    s_waitcnt lgkmcnt(10)
    v_mfma_f32_32x32x16_bf16 v[72:87], v[192:195], v[176:179], v[72:87]
    s_waitcnt lgkmcnt(8)
    v_mfma_f32_32x32x16_bf16 v[88:103], v[196:199], v[176:179], v[88:103]
    s_waitcnt lgkmcnt(6)
    v_mfma_f32_32x32x16_bf16 v[40:55], v[200:203], v[180:183], v[40:55]
    s_waitcnt lgkmcnt(4)
    v_mfma_f32_32x32x16_bf16 v[56:71], v[204:207], v[180:183], v[56:71]
    s_waitcnt lgkmcnt(2)
    v_mfma_f32_32x32x16_bf16 v[72:87], v[208:211], v[180:183], v[72:87]
    s_waitcnt lgkmcnt(0)
    v_mfma_f32_32x32x16_bf16 v[88:103], v[212:215], v[180:183], v[88:103]
    s_add_u32 s22, s22, 32768
    s_cmp_ge_u32 s22, 131072
    s_cselect_b32 s22, 0, s22
    s_add_u32 s23, s23, 32768
    s_cmp_ge_u32 s23, 131072
    s_cselect_b32 s23, 0, s23
    s_waitcnt vmcnt(4)
    s_barrier
    v_add_u32 v239, s22, v235
    v_xor_b32 v240, 32, v239
    v_xor_b32 v241, 64, v239
    v_xor_b32 v242, 96, v239
    v_xor_b32 v243, 128, v239
    v_xor_b32 v244, 160, v239
    v_xor_b32 v245, 192, v239
    v_xor_b32 v246, 224, v239
    v_add_u32 v247, s23, v236
    v_xor_b32 v248, 64, v247
    v_xor_b32 v249, 128, v247
    v_xor_b32 v250, 192, v247
    ds_read_b128 v[184:187], v239 offset:0
    ds_read_b128 v[188:191], v239 offset:8192
    ds_read_b128 v[192:195], v240 offset:0
    ds_read_b128 v[196:199], v240 offset:8192
    ds_read_b128 v[200:203], v241 offset:0
    ds_read_b128 v[204:207], v241 offset:8192
    ds_read_b128 v[208:211], v242 offset:0
    ds_read_b128 v[212:215], v242 offset:8192
    ds_read_b128 v[216:219], v243 offset:0
    ds_read_b128 v[220:223], v243 offset:8192
    ds_read_b128 v[224:227], v244 offset:0
    ds_read_b128 v[228:231], v244 offset:8192
    s_waitcnt lgkmcnt(11)
    v_mfma_f32_32x32x16_bf16 v[104:119], v[184:187], v[8:11], 0
    ds_read_b128 v[184:187], v245 offset:0
    v_max3_f32 v5, v136, v137, v138
    v_max3_f32 v6, v139, v140, v141
    v_max3_f32 v5, v142, v143, v5
    v_max3_f32 v6, v144, v145, v6
    v_max3_f32 v5, v146, v147, v5
    v_max3_f32 v6, v148, v149, v6
    v_max3_f32 v5, v150, v151, v5
    s_waitcnt lgkmcnt(11)
    v_mfma_f32_32x32x16_bf16 v[120:135], v[188:191], v[8:11], 0
    ds_read_b128 v[188:191], v245 offset:8192
    v_max3_f32 v6, v152, v153, v6
    v_max3_f32 v5, v154, v155, v5
    v_max3_f32 v6, v156, v157, v6
    v_max3_f32 v5, v158, v159, v5
    v_max3_f32 v6, v160, v161, v6
    v_max3_f32 v5, v162, v163, v5
    v_max3_f32 v6, v164, v165, v6
    s_waitcnt lgkmcnt(11)
    v_mfma_f32_32x32x16_bf16 v[104:119], v[192:195], v[12:15], v[104:119]
    ds_read_b128 v[192:195], v246 offset:0
    v_max3_f32 v5, v166, v167, v5
    v_max_f32 v5, v5, v6
    v_mov_b32 v6, v5
    s_nop 1
    v_permlane32_swap_b32 v5, v6
    v_max_f32 v5, v5, v6
    v_sub_f32 v6, v5, v1
    v_cmp_lt_f32 vcc, s30, v6
    s_nop 4
    s_cbranch_vccnz L_resc3
L_back3:
    s_waitcnt lgkmcnt(11)
    v_mfma_f32_32x32x16_bf16 v[120:135], v[196:199], v[12:15], v[120:135]
    ds_read_b128 v[196:199], v246 offset:8192
    v_fma_f32 v136, v136, s25, -v238
    v_fma_f32 v137, v137, s25, -v238
    v_exp_f32 v136, v136
    s_waitcnt lgkmcnt(11)
    v_mfma_f32_32x32x16_bf16 v[104:119], v[200:203], v[16:19], v[104:119]
    ds_read_b64_tr_b16 v[200:201], v247 offset:16384
    ds_read_b64_tr_b16 v[202:203], v247 offset:18432
    v_fma_f32 v138, v138, s25, -v238
    v_exp_f32 v137, v137
    v_fma_f32 v139, v139, s25, -v238
    v_exp_f32 v138, v138
    s_waitcnt lgkmcnt(12)
    v_mfma_f32_32x32x16_bf16 v[120:135], v[204:207], v[16:19], v[120:135]
    ds_read_b64_tr_b16 v[204:205], v248 offset:16384
    ds_read_b64_tr_b16 v[206:207], v248 offset:18432
    v_fma_f32 v140, v140, s25, -v238
    v_exp_f32 v139, v139
    v_cvt_pk_bf16_f32 v168, v136, v137
    v_fma_f32 v141, v141, s25, -v238
    v_exp_f32 v140, v140
    s_waitcnt lgkmcnt(13)
    v_mfma_f32_32x32x16_bf16 v[104:119], v[208:211], v[20:23], v[104:119]
    ds_read_b64_tr_b16 v[208:209], v249 offset:16384
    ds_read_b64_tr_b16 v[210:211], v249 offset:18432
    v_fma_f32 v142, v142, s25, -v238
    v_exp_f32 v141, v141
    v_cvt_pk_bf16_f32 v169, v138, v139
    v_fma_f32 v143, v143, s25, -v238
    v_exp_f32 v142, v142
    s_waitcnt lgkmcnt(14)
    v_mfma_f32_32x32x16_bf16 v[120:135], v[212:215], v[20:23], v[120:135]
    ds_read_b64_tr_b16 v[212:213], v250 offset:16384
    ds_read_b64_tr_b16 v[214:215], v250 offset:18432
    v_exp_f32 v143, v143
    v_cvt_pk_bf16_f32 v170, v140, v141
    v_add_f32 v2, v2, v136
    v_cvt_pk_bf16_f32 v171, v142, v143
    v_add_f32 v3, v3, v137
    s_waitcnt lgkmcnt(15)
    v_mfma_f32_32x32x16_bf16 v[104:119], v[216:219], v[24:27], v[104:119]
    ds_read_b64_tr_b16 v[216:217], v247 offset:20480
    ds_read_b64_tr_b16 v[218:219], v247 offset:22528
    v_add_f32 v2, v2, v138
    v_add_f32 v3, v3, v139
    v_add_f32 v2, v2, v140
    v_add_f32 v3, v3, v141
    v_add_f32 v2, v2, v142
    v_add_f32 v3, v3, v143
    s_waitcnt lgkmcnt(15)
    v_mfma_f32_32x32x16_bf16 v[120:135], v[220:223], v[24:27], v[120:135]
    ds_read_b64_tr_b16 v[220:221], v248 offset:20480
    ds_read_b64_tr_b16 v[222:223], v248 offset:22528
    v_fma_f32 v144, v144, s25, -v238
    v_fma_f32 v145, v145, s25, -v238
    v_exp_f32 v144, v144
    v_fma_f32 v146, v146, s25, -v238
    v_exp_f32 v145, v145
    s_waitcnt lgkmcnt(15)
    v_mfma_f32_32x32x16_bf16 v[104:119], v[224:227], v[28:31], v[104:119]
    ds_read_b64_tr_b16 v[224:225], v249 offset:20480
    ds_read_b64_tr_b16 v[226:227], v249 offset:22528
    v_fma_f32 v147, v147, s25, -v238
    v_exp_f32 v146, v146
    v_fma_f32 v148, v148, s25, -v238
    v_exp_f32 v147, v147
    s_waitcnt lgkmcnt(15)
    v_mfma_f32_32x32x16_bf16 v[120:135], v[228:231], v[28:31], v[120:135]
    ds_read_b64_tr_b16 v[228:229], v250 offset:20480
    ds_read_b64_tr_b16 v[230:231], v250 offset:22528
    v_cvt_pk_bf16_f32 v172, v144, v145
    v_fma_f32 v149, v149, s25, -v238
    v_exp_f32 v148, v148
    v_fma_f32 v150, v150, s25, -v238
    v_exp_f32 v149, v149
    s_waitcnt lgkmcnt(15)
    v_mfma_f32_32x32x16_bf16 v[104:119], v[184:187], v[32:35], v[104:119]
    ds_read_b64_tr_b16 v[184:185], v247 offset:24576
    ds_read_b64_tr_b16 v[186:187], v247 offset:26624
    v_cvt_pk_bf16_f32 v173, v146, v147
    v_fma_f32 v151, v151, s25, -v238
    v_exp_f32 v150, v150
    v_exp_f32 v151, v151
    s_waitcnt lgkmcnt(15)
    v_mfma_f32_32x32x16_bf16 v[120:135], v[188:191], v[32:35], v[120:135]
    ds_read_b64_tr_b16 v[188:189], v248 offset:24576
    ds_read_b64_tr_b16 v[190:191], v248 offset:26624
    v_cvt_pk_bf16_f32 v174, v148, v149
    v_add_f32 v2, v2, v144
    v_cvt_pk_bf16_f32 v175, v150, v151
    v_add_f32 v3, v3, v145
    v_add_f32 v2, v2, v146
    v_add_f32 v3, v3, v147
    v_add_f32 v2, v2, v148
    s_waitcnt lgkmcnt(15)
    v_mfma_f32_32x32x16_bf16 v[104:119], v[192:195], v[36:39], v[104:119]
    ds_read_b64_tr_b16 v[192:193], v249 offset:24576
    ds_read_b64_tr_b16 v[194:195], v249 offset:26624
    v_add_f32 v3, v3, v149
    v_add_f32 v2, v2, v150
    v_add_f32 v3, v3, v151
    v_fma_f32 v152, v152, s25, -v238
    v_fma_f32 v153, v153, s25, -v238
    v_exp_f32 v152, v152
    s_waitcnt lgkmcnt(15)
    v_mfma_f32_32x32x16_bf16 v[120:135], v[196:199], v[36:39], v[120:135]
    ds_read_b64_tr_b16 v[196:197], v250 offset:24576
    ds_read_b64_tr_b16 v[198:199], v250 offset:26624
    v_fma_f32 v154, v154, s25, -v238
    v_exp_f32 v153, v153
    v_fma_f32 v155, v155, s25, -v238
    v_exp_f32 v154, v154
    s_waitcnt lgkmcnt(15)
    v_mfma_f32_32x32x16_bf16 v[40:55], v[200:203], v[168:171], v[40:55]
    ds_read_b64_tr_b16 v[200:201], v247 offset:28672
    ds_read_b64_tr_b16 v[202:203], v247 offset:30720
    v_fma_f32 v156, v156, s25, -v238
    v_exp_f32 v155, v155
    v_cvt_pk_bf16_f32 v176, v152, v153
    v_fma_f32 v157, v157, s25, -v238
    v_exp_f32 v156, v156
    s_waitcnt lgkmcnt(15)
    v_mfma_f32_32x32x16_bf16 v[56:71], v[204:207], v[168:171], v[56:71]
    ds_read_b64_tr_b16 v[204:205], v248 offset:28672
    ds_read_b64_tr_b16 v[206:207], v248 offset:30720
    v_fma_f32 v158, v158, s25, -v238
    v_exp_f32 v157, v157
    v_cvt_pk_bf16_f32 v177, v154, v155
    v_fma_f32 v159, v159, s25, -v238
    v_exp_f32 v158, v158
    s_waitcnt lgkmcnt(15)
    v_mfma_f32_32x32x16_bf16 v[72:87], v[208:211], v[168:171], v[72:87]
    ds_read_b64_tr_b16 v[208:209], v249 offset:28672
    ds_read_b64_tr_b16 v[210:211], v249 offset:30720
    v_exp_f32 v159, v159
    v_cvt_pk_bf16_f32 v178, v156, v157
    v_add_f32 v2, v2, v152
    v_cvt_pk_bf16_f32 v179, v158, v159
    s_waitcnt lgkmcnt(15)
    v_mfma_f32_32x32x16_bf16 v[88:103], v[212:215], v[168:171], v[88:103]
    ds_read_b64_tr_b16 v[212:213], v250 offset:28672
    ds_read_b64_tr_b16 v[214:215], v250 offset:30720
    v_add_f32 v3, v3, v153
    v_add_f32 v2, v2, v154
    v_add_f32 v3, v3, v155
    v_add_f32 v2, v2, v156
    v_add_f32 v3, v3, v157
    v_add_f32 v2, v2, v158
    v_add_f32 v3, v3, v159
    s_waitcnt lgkmcnt(15)
    v_mfma_f32_32x32x16_bf16 v[40:55], v[216:219], v[172:175], v[40:55]
    v_fma_f32 v160, v160, s25, -v238
    v_fma_f32 v161, v161, s25, -v238
    v_exp_f32 v160, v160
    v_fma_f32 v162, v162, s25, -v238
    v_exp_f32 v161, v161
    s_waitcnt lgkmcnt(15)
    v_mfma_f32_32x32x16_bf16 v[56:71], v[220:223], v[172:175], v[56:71]
    v_fma_f32 v163, v163, s25, -v238
    v_exp_f32 v162, v162
    v_fma_f32 v164, v164, s25, -v238
    v_exp_f32 v163, v163
    s_waitcnt lgkmcnt(15)
    v_mfma_f32_32x32x16_bf16 v[72:87], v[224:227], v[172:175], v[72:87]
    v_cvt_pk_bf16_f32 v180, v160, v161
    v_fma_f32 v165, v165, s25, -v238
    v_exp_f32 v164, v164
    v_fma_f32 v166, v166, s25, -v238
    v_exp_f32 v165, v165
    s_waitcnt lgkmcnt(15)
    v_mfma_f32_32x32x16_bf16 v[88:103], v[228:231], v[172:175], v[88:103]
    v_cvt_pk_bf16_f32 v181, v162, v163
    v_fma_f32 v167, v167, s25, -v238
    v_exp_f32 v166, v166
    v_exp_f32 v167, v167
    s_waitcnt lgkmcnt(14)
    v_mfma_f32_32x32x16_bf16 v[40:55], v[184:187], v[176:179], v[40:55]
    v_cvt_pk_bf16_f32 v182, v164, v165
    v_add_f32 v2, v2, v160
    v_cvt_pk_bf16_f32 v183, v166, v167
    v_add_f32 v3, v3, v161
    v_add_f32 v2, v2, v162
    v_add_f32 v3, v3, v163
    v_add_f32 v2, v2, v164
    s_waitcnt lgkmcnt(12)
    v_mfma_f32_32x32x16_bf16 v[56:71], v[188:191], v[176:179], v[56:71]
    v_add_f32 v3, v3, v165
    v_add_f32 v2, v2, v166
    v_add_f32 v3, v3, v167
    s_waitcnt lgkmcnt(10)
    v_mfma_f32_32x32x16_bf16 v[72:87], v[192:195], v[176:179], v[72:87]
    s_waitcnt lgkmcnt(8)
    v_mfma_f32_32x32x16_bf16 v[88:103], v[196:199], v[176:179], v[88:103]
    s_waitcnt lgkmcnt(6)
    v_mfma_f32_32x32x16_bf16 v[40:55], v[200:203], v[180:183], v[40:55]
    s_waitcnt lgkmcnt(4)
    v_mfma_f32_32x32x16_bf16 v[56:71], v[204:207], v[180:183], v[56:71]
    s_waitcnt lgkmcnt(2)
    v_mfma_f32_32x32x16_bf16 v[72:87], v[208:211], v[180:183], v[72:87]
    s_waitcnt lgkmcnt(0)
    v_mfma_f32_32x32x16_bf16 v[88:103], v[212:215], v[180:183], v[88:103]
    s_add_u32 s22, s22, 32768
    s_cmp_ge_u32 s22, 131072
    s_cselect_b32 s22, 0, s22
    s_add_u32 s23, s23, 32768
    s_cmp_ge_u32 s23, 131072
    s_cselect_b32 s23, 0, s23
    s_waitcnt vmcnt(0)
    s_barrier
    v_add_u32 v239, s22, v235
    v_xor_b32 v240, 32, v239
    v_xor_b32 v241, 64, v239
    v_xor_b32 v242, 96, v239
    v_xor_b32 v243, 128, v239
    v_xor_b32 v244, 160, v239
    v_xor_b32 v245, 192, v239
    v_xor_b32 v246, 224, v239
    v_add_u32 v247, s23, v236
    v_xor_b32 v248, 64, v247
    v_xor_b32 v249, 128, v247
    v_xor_b32 v250, 192, v247
    ds_read_b128 v[184:187], v239 offset:0
    ds_read_b128 v[188:191], v239 offset:8192
    ds_read_b128 v[192:195], v240 offset:0
    ds_read_b128 v[196:199], v240 offset:8192
    ds_read_b128 v[200:203], v241 offset:0
    ds_read_b128 v[204:207], v241 offset:8192
    ds_read_b128 v[208:211], v242 offset:0
    ds_read_b128 v[212:215], v242 offset:8192
    ds_read_b128 v[216:219], v243 offset:0
    ds_read_b128 v[220:223], v243 offset:8192
    ds_read_b128 v[224:227], v244 offset:0
    ds_read_b128 v[228:231], v244 offset:8192
    s_waitcnt lgkmcnt(11)
    v_mfma_f32_32x32x16_bf16 v[136:151], v[184:187], v[8:11], 0
    ds_read_b128 v[184:187], v245 offset:0
    v_max3_f32 v5, v104, v105, v106
    v_max3_f32 v6, v107, v108, v109
    v_max3_f32 v5, v110, v111, v5
    v_max3_f32 v6, v112, v113, v6
    v_max3_f32 v5, v114, v115, v5
    v_max3_f32 v6, v116, v117, v6
    v_max3_f32 v5, v118, v119, v5
    s_waitcnt lgkmcnt(11)
    v_mfma_f32_32x32x16_bf16 v[152:167], v[188:191], v[8:11], 0
    ds_read_b128 v[188:191], v245 offset:8192
    v_max3_f32 v6, v120, v121, v6
    v_max3_f32 v5, v122, v123, v5
    v_max3_f32 v6, v124, v125, v6
    v_max3_f32 v5, v126, v127, v5
    v_max3_f32 v6, v128, v129, v6
    v_max3_f32 v5, v130, v131, v5
    v_max3_f32 v6, v132, v133, v6
    s_waitcnt lgkmcnt(11)
    v_mfma_f32_32x32x16_bf16 v[136:151], v[192:195], v[12:15], v[136:151]
    ds_read_b128 v[192:195], v246 offset:0
    v_max3_f32 v5, v134, v135, v5
    v_max_f32 v5, v5, v6
    v_mov_b32 v6, v5
    s_nop 1
    v_permlane32_swap_b32 v5, v6
    v_max_f32 v5, v5, v6
    v_sub_f32 v6, v5, v1
    v_cmp_lt_f32 vcc, s30, v6
    s_nop 4
    s_cbranch_vccnz L_resc4
L_back4:
    s_waitcnt lgkmcnt(11)
    v_mfma_f32_32x32x16_bf16 v[152:167], v[196:199], v[12:15], v[152:167]
    ds_read_b128 v[196:199], v246 offset:8192
    v_fma_f32 v104, v104, s25, -v238
    v_fma_f32 v105, v105, s25, -v238
    v_exp_f32 v104, v104
    s_waitcnt lgkmcnt(11)
    v_mfma_f32_32x32x16_bf16 v[136:151], v[200:203], v[16:19], v[136:151]
    ds_read_b64_tr_b16 v[200:201], v247 offset:16384
    ds_read_b64_tr_b16 v[202:203], v247 offset:18432
    v_fma_f32 v106, v106, s25, -v238
    v_exp_f32 v105, v105
    v_fma_f32 v107, v107, s25, -v238
    v_exp_f32 v106, v106
    s_waitcnt lgkmcnt(12)
    v_mfma_f32_32x32x16_bf16 v[152:167], v[204:207], v[16:19], v[152:167]
    ds_read_b64_tr_b16 v[204:205], v248 offset:16384
    ds_read_b64_tr_b16 v[206:207], v248 offset:18432
    v_fma_f32 v108, v108, s25, -v238
    v_exp_f32 v107, v107
    v_cvt_pk_bf16_f32 v168, v104, v105
    v_fma_f32 v109, v109, s25, -v238
    v_exp_f32 v108, v108
    s_waitcnt lgkmcnt(13)
    v_mfma_f32_32x32x16_bf16 v[136:151], v[208:211], v[20:23], v[136:151]
    ds_read_b64_tr_b16 v[208:209], v249 offset:16384
    ds_read_b64_tr_b16 v[210:211], v249 offset:18432
    v_fma_f32 v110, v110, s25, -v238
    v_exp_f32 v109, v109
    v_cvt_pk_bf16_f32 v169, v106, v107
    v_fma_f32 v111, v111, s25, -v238
    v_exp_f32 v110, v110
    s_waitcnt lgkmcnt(14)
    v_mfma_f32_32x32x16_bf16 v[152:167], v[212:215], v[20:23], v[152:167]
    ds_read_b64_tr_b16 v[212:213], v250 offset:16384
    ds_read_b64_tr_b16 v[214:215], v250 offset:18432
    v_exp_f32 v111, v111
    v_cvt_pk_bf16_f32 v170, v108, v109
    v_add_f32 v2, v2, v104
    v_cvt_pk_bf16_f32 v171, v110, v111
    v_add_f32 v3, v3, v105
    s_waitcnt lgkmcnt(15)
    v_mfma_f32_32x32x16_bf16 v[136:151], v[216:219], v[24:27], v[136:151]
    ds_read_b64_tr_b16 v[216:217], v247 offset:20480
    ds_read_b64_tr_b16 v[218:219], v247 offset:22528
    v_add_f32 v2, v2, v106
    v_add_f32 v3, v3, v107
    v_add_f32 v2, v2, v108
    v_add_f32 v3, v3, v109
    v_add_f32 v2, v2, v110
    v_add_f32 v3, v3, v111
    s_waitcnt lgkmcnt(15)
    v_mfma_f32_32x32x16_bf16 v[152:167], v[220:223], v[24:27], v[152:167]
    ds_read_b64_tr_b16 v[220:221], v248 offset:20480
    ds_read_b64_tr_b16 v[222:223], v248 offset:22528
    v_fma_f32 v112, v112, s25, -v238
    v_fma_f32 v113, v113, s25, -v238
    v_exp_f32 v112, v112
    v_fma_f32 v114, v114, s25, -v238
    v_exp_f32 v113, v113
    s_waitcnt lgkmcnt(15)
    v_mfma_f32_32x32x16_bf16 v[136:151], v[224:227], v[28:31], v[136:151]
    ds_read_b64_tr_b16 v[224:225], v249 offset:20480
    ds_read_b64_tr_b16 v[226:227], v249 offset:22528
    v_fma_f32 v115, v115, s25, -v238
    v_exp_f32 v114, v114
    v_fma_f32 v116, v116, s25, -v238
    v_exp_f32 v115, v115
    s_waitcnt lgkmcnt(15)
    v_mfma_f32_32x32x16_bf16 v[152:167], v[228:231], v[28:31], v[152:167]
    ds_read_b64_tr_b16 v[228:229], v250 offset:20480
    ds_read_b64_tr_b16 v[230:231], v250 offset:22528
    v_cvt_pk_bf16_f32 v172, v112, v113
    v_fma_f32 v117, v117, s25, -v238
    v_exp_f32 v116, v116
    v_fma_f32 v118, v118, s25, -v238
    v_exp_f32 v117, v117
    s_waitcnt lgkmcnt(15)
    v_mfma_f32_32x32x16_bf16 v[136:151], v[184:187], v[32:35], v[136:151]
    ds_read_b64_tr_b16 v[184:185], v247 offset:24576
    ds_read_b64_tr_b16 v[186:187], v247 offset:26624
    v_cvt_pk_bf16_f32 v173, v114, v115
    v_fma_f32 v119, v119, s25, -v238
    v_exp_f32 v118, v118
    v_exp_f32 v119, v119
    s_waitcnt lgkmcnt(15)
    v_mfma_f32_32x32x16_bf16 v[152:167], v[188:191], v[32:35], v[152:167]
    ds_read_b64_tr_b16 v[188:189], v248 offset:24576
    ds_read_b64_tr_b16 v[190:191], v248 offset:26624
    v_cvt_pk_bf16_f32 v174, v116, v117
    v_add_f32 v2, v2, v112
    v_cvt_pk_bf16_f32 v175, v118, v119
    v_add_f32 v3, v3, v113
    v_add_f32 v2, v2, v114
    v_add_f32 v3, v3, v115
    v_add_f32 v2, v2, v116
    s_waitcnt lgkmcnt(15)
    v_mfma_f32_32x32x16_bf16 v[136:151], v[192:195], v[36:39], v[136:151]
    ds_read_b64_tr_b16 v[192:193], v249 offset:24576
    ds_read_b64_tr_b16 v[194:195], v249 offset:26624
    v_add_f32 v3, v3, v117
    v_add_f32 v2, v2, v118
    v_add_f32 v3, v3, v119
    v_fma_f32 v120, v120, s25, -v238
    v_fma_f32 v121, v121, s25, -v238
    v_exp_f32 v120, v120
    s_waitcnt lgkmcnt(15)
    v_mfma_f32_32x32x16_bf16 v[152:167], v[196:199], v[36:39], v[152:167]
    ds_read_b64_tr_b16 v[196:197], v250 offset:24576
    ds_read_b64_tr_b16 v[198:199], v250 offset:26624
    v_fma_f32 v122, v122, s25, -v238
    v_exp_f32 v121, v121
    v_fma_f32 v123, v123, s25, -v238
    v_exp_f32 v122, v122
    s_waitcnt lgkmcnt(15)
    v_mfma_f32_32x32x16_bf16 v[40:55], v[200:203], v[168:171], v[40:55]
    ds_read_b64_tr_b16 v[200:201], v247 offset:28672
    ds_read_b64_tr_b16 v[202:203], v247 offset:30720
    v_fma_f32 v124, v124, s25, -v238
    v_exp_f32 v123, v123
    v_cvt_pk_bf16_f32 v176, v120, v121
    v_fma_f32 v125, v125, s25, -v238
    v_exp_f32 v124, v124
    s_waitcnt lgkmcnt(15)
    v_mfma_f32_32x32x16_bf16 v[56:71], v[204:207], v[168:171], v[56:71]
    ds_read_b64_tr_b16 v[204:205], v248 offset:28672
    ds_read_b64_tr_b16 v[206:207], v248 offset:30720
    v_fma_f32 v126, v126, s25, -v238
    v_exp_f32 v125, v125
    v_cvt_pk_bf16_f32 v177, v122, v123
    v_fma_f32 v127, v127, s25, -v238
    v_exp_f32 v126, v126
    s_waitcnt lgkmcnt(15)
    v_mfma_f32_32x32x16_bf16 v[72:87], v[208:211], v[168:171], v[72:87]
    ds_read_b64_tr_b16 v[208:209], v249 offset:28672
    ds_read_b64_tr_b16 v[210:211], v249 offset:30720
    v_exp_f32 v127, v127
    v_cvt_pk_bf16_f32 v178, v124, v125
    v_add_f32 v2, v2, v120
    v_cvt_pk_bf16_f32 v179, v126, v127
    s_waitcnt lgkmcnt(15)
    v_mfma_f32_32x32x16_bf16 v[88:103], v[212:215], v[168:171], v[88:103]
    ds_read_b64_tr_b16 v[212:213], v250 offset:28672
    ds_read_b64_tr_b16 v[214:215], v250 offset:30720
    v_add_f32 v3, v3, v121
    v_add_f32 v2, v2, v122
    v_add_f32 v3, v3, v123
    v_add_f32 v2, v2, v124
    v_add_f32 v3, v3, v125
    v_add_f32 v2, v2, v126
    v_add_f32 v3, v3, v127
    s_waitcnt lgkmcnt(15)
    v_mfma_f32_32x32x16_bf16 v[40:55], v[216:219], v[172:175], v[40:55]
    v_fma_f32 v128, v128, s25, -v238
    v_fma_f32 v129, v129, s25, -v238
    v_exp_f32 v128, v128
    v_fma_f32 v130, v130, s25, -v238
    v_exp_f32 v129, v129
    s_waitcnt lgkmcnt(15)
    v_mfma_f32_32x32x16_bf16 v[56:71], v[220:223], v[172:175], v[56:71]
    v_fma_f32 v131, v131, s25, -v238
    v_exp_f32 v130, v130
    v_fma_f32 v132, v132, s25, -v238
    v_exp_f32 v131, v131
    s_waitcnt lgkmcnt(15)
    v_mfma_f32_32x32x16_bf16 v[72:87], v[224:227], v[172:175], v[72:87]
    v_cvt_pk_bf16_f32 v180, v128, v129
    v_fma_f32 v133, v133, s25, -v238
    v_exp_f32 v132, v132
    v_fma_f32 v134, v134, s25, -v238
    v_exp_f32 v133, v133
    s_waitcnt lgkmcnt(15)
    v_mfma_f32_32x32x16_bf16 v[88:103], v[228:231], v[172:175], v[88:103]
    v_cvt_pk_bf16_f32 v181, v130, v131
    v_fma_f32 v135, v135, s25, -v238
    v_exp_f32 v134, v134
    v_exp_f32 v135, v135
    s_waitcnt lgkmcnt(14)
    v_mfma_f32_32x32x16_bf16 v[40:55], v[184:187], v[176:179], v[40:55]
    v_cvt_pk_bf16_f32 v182, v132, v133
    v_add_f32 v2, v2, v128
    v_cvt_pk_bf16_f32 v183, v134, v135
    v_add_f32 v3, v3, v129
    v_add_f32 v2, v2, v130
    v_add_f32 v3, v3, v131
    v_add_f32 v2, v2, v132
    s_waitcnt lgkmcnt(12)
    v_mfma_f32_32x32x16_bf16 v[56:71], v[188:191], v[176:179], v[56:71]
    v_add_f32 v3, v3, v133
    v_add_f32 v2, v2, v134
    v_add_f32 v3, v3, v135
    s_waitcnt lgkmcnt(10)
    v_mfma_f32_32x32x16_bf16 v[72:87], v[192:195], v[176:179], v[72:87]
    s_waitcnt lgkmcnt(8)
    v_mfma_f32_32x32x16_bf16 v[88:103], v[196:199], v[176:179], v[88:103]
    s_waitcnt lgkmcnt(6)
    v_mfma_f32_32x32x16_bf16 v[40:55], v[200:203], v[180:183], v[40:55]
    s_waitcnt lgkmcnt(4)
    v_mfma_f32_32x32x16_bf16 v[56:71], v[204:207], v[180:183], v[56:71]
    s_waitcnt lgkmcnt(2)
    v_mfma_f32_32x32x16_bf16 v[72:87], v[208:211], v[180:183], v[72:87]
    s_waitcnt lgkmcnt(0)
    v_mfma_f32_32x32x16_bf16 v[88:103], v[212:215], v[180:183], v[88:103]
    s_add_u32 s22, s22, 32768
    s_cmp_ge_u32 s22, 131072
    s_cselect_b32 s22, 0, s22
    s_add_u32 s23, s23, 32768
    s_cmp_ge_u32 s23, 131072
    s_cselect_b32 s23, 0, s23
    v_add_u32 v247, s23, v236
    v_xor_b32 v248, 64, v247
    v_xor_b32 v249, 128, v247
    v_xor_b32 v250, 192, v247
    ds_read_b64_tr_b16 v[184:185], v247 offset:16384
    ds_read_b64_tr_b16 v[186:187], v247 offset:18432
    ds_read_b64_tr_b16 v[188:189], v248 offset:16384
    ds_read_b64_tr_b16 v[190:191], v248 offset:18432
    ds_read_b64_tr_b16 v[192:193], v249 offset:16384
    ds_read_b64_tr_b16 v[194:195], v249 offset:18432
    ds_read_b64_tr_b16 v[196:197], v250 offset:16384
    ds_read_b64_tr_b16 v[198:199], v250 offset:18432
    ds_read_b64_tr_b16 v[200:201], v247 offset:20480
    ds_read_b64_tr_b16 v[202:203], v247 offset:22528
    ds_read_b64_tr_b16 v[204:205], v248 offset:20480
    ds_read_b64_tr_b16 v[206:207], v248 offset:22528
    ds_read_b64_tr_b16 v[208:209], v249 offset:20480
    ds_read_b64_tr_b16 v[210:211], v249 offset:22528
    ds_read_b64_tr_b16 v[212:213], v250 offset:20480
    ds_read_b64_tr_b16 v[214:215], v250 offset:22528
    ds_read_b64_tr_b16 v[216:217], v247 offset:24576
    ds_read_b64_tr_b16 v[218:219], v247 offset:26624
    ds_read_b64_tr_b16 v[220:221], v248 offset:24576
    ds_read_b64_tr_b16 v[222:223], v248 offset:26624
    ds_read_b64_tr_b16 v[224:225], v249 offset:24576
    ds_read_b64_tr_b16 v[226:227], v249 offset:26624
    ds_read_b64_tr_b16 v[228:229], v250 offset:24576
    ds_read_b64_tr_b16 v[230:231], v250 offset:26624
    v_max3_f32 v5, v136, v137, v138
    v_max3_f32 v6, v139, v140, v141
    v_max3_f32 v5, v142, v143, v5
    v_max3_f32 v6, v144, v145, v6
    v_max3_f32 v5, v146, v147, v5
    v_max3_f32 v6, v148, v149, v6
    v_max3_f32 v5, v150, v151, v5
    v_max3_f32 v6, v152, v153, v6
    v_max3_f32 v5, v154, v155, v5
    v_max3_f32 v6, v156, v157, v6
    v_max3_f32 v5, v158, v159, v5
    v_max3_f32 v6, v160, v161, v6
    v_max3_f32 v5, v162, v163, v5
    v_max3_f32 v6, v164, v165, v6
    v_max3_f32 v5, v166, v167, v5
    v_max_f32 v5, v5, v6
    v_mov_b32 v6, v5
    s_nop 1
    v_permlane32_swap_b32 v5, v6
    v_max_f32 v5, v5, v6
    v_sub_f32 v6, v5, v1
    v_cmp_lt_f32 vcc, s30, v6
    s_nop 4
    s_cbranch_vccnz L_resc5
L_back5:
    v_fma_f32 v136, v136, s25, -v238
    v_fma_f32 v137, v137, s25, -v238
    v_exp_f32 v136, v136
    v_fma_f32 v138, v138, s25, -v238
    v_exp_f32 v137, v137
    v_fma_f32 v139, v139, s25, -v238
    v_exp_f32 v138, v138
    v_fma_f32 v140, v140, s25, -v238
    v_exp_f32 v139, v139
    v_cvt_pk_bf16_f32 v168, v136, v137
    v_fma_f32 v141, v141, s25, -v238
    v_exp_f32 v140, v140
    v_fma_f32 v142, v142, s25, -v238
    v_exp_f32 v141, v141
    v_cvt_pk_bf16_f32 v169, v138, v139
    v_fma_f32 v143, v143, s25, -v238
    v_exp_f32 v142, v142
    v_exp_f32 v143, v143
    v_cvt_pk_bf16_f32 v170, v140, v141
    v_add_f32 v2, v2, v136
    v_cvt_pk_bf16_f32 v171, v142, v143
    s_nop 1
    s_waitcnt lgkmcnt(15)
    v_mfma_f32_32x32x16_bf16 v[40:55], v[184:187], v[168:171], v[40:55]
    ds_read_b64_tr_b16 v[184:185], v247 offset:28672
    ds_read_b64_tr_b16 v[186:187], v247 offset:30720
    s_waitcnt lgkmcnt(15)
    v_mfma_f32_32x32x16_bf16 v[56:71], v[188:191], v[168:171], v[56:71]
    ds_read_b64_tr_b16 v[188:189], v248 offset:28672
    ds_read_b64_tr_b16 v[190:191], v248 offset:30720
    s_waitcnt lgkmcnt(15)
    v_mfma_f32_32x32x16_bf16 v[72:87], v[192:195], v[168:171], v[72:87]
    ds_read_b64_tr_b16 v[192:193], v249 offset:28672
    ds_read_b64_tr_b16 v[194:195], v249 offset:30720
    s_waitcnt lgkmcnt(15)
    v_mfma_f32_32x32x16_bf16 v[88:103], v[196:199], v[168:171], v[88:103]
    ds_read_b64_tr_b16 v[196:197], v250 offset:28672
    ds_read_b64_tr_b16 v[198:199], v250 offset:30720
    v_add_f32 v3, v3, v137
    v_add_f32 v2, v2, v138
    v_add_f32 v3, v3, v139
    v_add_f32 v2, v2, v140
    v_add_f32 v3, v3, v141
    v_add_f32 v2, v2, v142
    v_add_f32 v3, v3, v143
    v_fma_f32 v144, v144, s25, -v238
    v_fma_f32 v145, v145, s25, -v238
    v_exp_f32 v144, v144
    v_fma_f32 v146, v146, s25, -v238
    v_exp_f32 v145, v145
    v_fma_f32 v147, v147, s25, -v238
    v_exp_f32 v146, v146
    v_fma_f32 v148, v148, s25, -v238
    v_exp_f32 v147, v147
    v_cvt_pk_bf16_f32 v172, v144, v145
    v_fma_f32 v149, v149, s25, -v238
    v_exp_f32 v148, v148
    v_fma_f32 v150, v150, s25, -v238
    v_exp_f32 v149, v149
    v_cvt_pk_bf16_f32 v173, v146, v147
    v_fma_f32 v151, v151, s25, -v238
    v_exp_f32 v150, v150
    v_exp_f32 v151, v151
    v_cvt_pk_bf16_f32 v174, v148, v149
    v_add_f32 v2, v2, v144
    v_cvt_pk_bf16_f32 v175, v150, v151
    s_nop 1
    s_waitcnt lgkmcnt(15)
    v_mfma_f32_32x32x16_bf16 v[40:55], v[200:203], v[172:175], v[40:55]
    s_waitcnt lgkmcnt(15)
    v_mfma_f32_32x32x16_bf16 v[56:71], v[204:207], v[172:175], v[56:71]
    s_waitcnt lgkmcnt(15)
    v_mfma_f32_32x32x16_bf16 v[72:87], v[208:211], v[172:175], v[72:87]
    s_waitcnt lgkmcnt(15)
    v_mfma_f32_32x32x16_bf16 v[88:103], v[212:215], v[172:175], v[88:103]
    v_add_f32 v3, v3, v145
    v_add_f32 v2, v2, v146
    v_add_f32 v3, v3, v147
    v_add_f32 v2, v2, v148
    v_add_f32 v3, v3, v149
    v_add_f32 v2, v2, v150
    v_add_f32 v3, v3, v151
    v_fma_f32 v152, v152, s25, -v238
    v_fma_f32 v153, v153, s25, -v238
    v_exp_f32 v152, v152
    v_fma_f32 v154, v154, s25, -v238
    v_exp_f32 v153, v153
    v_fma_f32 v155, v155, s25, -v238
    v_exp_f32 v154, v154
    v_fma_f32 v156, v156, s25, -v238
    v_exp_f32 v155, v155
    v_cvt_pk_bf16_f32 v176, v152, v153
    v_fma_f32 v157, v157, s25, -v238
    v_exp_f32 v156, v156
    v_fma_f32 v158, v158, s25, -v238
    v_exp_f32 v157, v157
    v_cvt_pk_bf16_f32 v177, v154, v155
    v_fma_f32 v159, v159, s25, -v238
    v_exp_f32 v158, v158
    v_exp_f32 v159, v159
    v_cvt_pk_bf16_f32 v178, v156, v157
    v_add_f32 v2, v2, v152
    v_cvt_pk_bf16_f32 v179, v158, v159
    s_nop 1
    s_waitcnt lgkmcnt(14)
    v_mfma_f32_32x32x16_bf16 v[40:55], v[216:219], v[176:179], v[40:55]
    s_waitcnt lgkmcnt(12)
    v_mfma_f32_32x32x16_bf16 v[56:71], v[220:223], v[176:179], v[56:71]
    s_waitcnt lgkmcnt(10)
    v_mfma_f32_32x32x16_bf16 v[72:87], v[224:227], v[176:179], v[72:87]
    s_waitcnt lgkmcnt(8)
    v_mfma_f32_32x32x16_bf16 v[88:103], v[228:231], v[176:179], v[88:103]
    v_add_f32 v3, v3, v153
    v_add_f32 v2, v2, v154
    v_add_f32 v3, v3, v155
    v_add_f32 v2, v2, v156
    v_add_f32 v3, v3, v157
    v_add_f32 v2, v2, v158
    v_add_f32 v3, v3, v159
    v_fma_f32 v160, v160, s25, -v238
    v_fma_f32 v161, v161, s25, -v238
    v_exp_f32 v160, v160
    v_fma_f32 v162, v162, s25, -v238
    v_exp_f32 v161, v161
    v_fma_f32 v163, v163, s25, -v238
    v_exp_f32 v162, v162
    v_fma_f32 v164, v164, s25, -v238
    v_exp_f32 v163, v163
    v_cvt_pk_bf16_f32 v180, v160, v161
    v_fma_f32 v165, v165, s25, -v238
    v_exp_f32 v164, v164
    v_fma_f32 v166, v166, s25, -v238
    v_exp_f32 v165, v165
    v_cvt_pk_bf16_f32 v181, v162, v163
    v_fma_f32 v167, v167, s25, -v238
    v_exp_f32 v166, v166
    v_exp_f32 v167, v167
    v_cvt_pk_bf16_f32 v182, v164, v165
    v_add_f32 v2, v2, v160
    v_cvt_pk_bf16_f32 v183, v166, v167
    s_nop 1
    s_waitcnt lgkmcnt(6)
    v_mfma_f32_32x32x16_bf16 v[40:55], v[184:187], v[180:183], v[40:55]
    s_waitcnt lgkmcnt(4)
    v_mfma_f32_32x32x16_bf16 v[56:71], v[188:191], v[180:183], v[56:71]
    s_waitcnt lgkmcnt(2)
    v_mfma_f32_32x32x16_bf16 v[72:87], v[192:195], v[180:183], v[72:87]
    s_waitcnt lgkmcnt(0)
    v_mfma_f32_32x32x16_bf16 v[88:103], v[196:199], v[180:183], v[88:103]
    v_add_f32 v3, v3, v161
    v_add_f32 v2, v2, v162
    v_add_f32 v3, v3, v163
    v_add_f32 v2, v2, v164
    v_add_f32 v3, v3, v165
    v_add_f32 v2, v2, v166
    v_add_f32 v3, v3, v167
    s_add_u32 s23, s23, 32768
    s_cmp_ge_u32 s23, 131072
    s_cselect_b32 s23, 0, s23
    v_add_f32 v2, v2, v3
    v_mov_b32 v5, v2
    s_nop 1
    v_permlane32_swap_b32 v2, v5
    v_add_f32 v2, v2, v5
    v_rcp_f32 v2, v2
    s_nop 15
    s_nop 7
    v_mul_f32 v40, v40, v2
    v_mul_f32 v41, v41, v2
    v_mul_f32 v42, v42, v2
    v_mul_f32 v43, v43, v2
    v_mul_f32 v44, v44, v2
    v_mul_f32 v45, v45, v2
    v_mul_f32 v46, v46, v2
    v_mul_f32 v47, v47, v2
    v_mul_f32 v48, v48, v2
    v_mul_f32 v49, v49, v2
    v_mul_f32 v50, v50, v2
    v_mul_f32 v51, v51, v2
    v_mul_f32 v52, v52, v2
    v_mul_f32 v53, v53, v2
    v_mul_f32 v54, v54, v2
    v_mul_f32 v55, v55, v2
    v_mul_f32 v56, v56, v2
    v_mul_f32 v57, v57, v2
    v_mul_f32 v58, v58, v2
    v_mul_f32 v59, v59, v2
    v_mul_f32 v60, v60, v2
    v_mul_f32 v61, v61, v2
    v_mul_f32 v62, v62, v2
    v_mul_f32 v63, v63, v2
    v_mul_f32 v64, v64, v2
    v_mul_f32 v65, v65, v2
    v_mul_f32 v66, v66, v2
    v_mul_f32 v67, v67, v2
    v_mul_f32 v68, v68, v2
    v_mul_f32 v69, v69, v2
    v_mul_f32 v70, v70, v2
    v_mul_f32 v71, v71, v2
    v_mul_f32 v72, v72, v2
    v_mul_f32 v73, v73, v2
    v_mul_f32 v74, v74, v2
    v_mul_f32 v75, v75, v2
    v_mul_f32 v76, v76, v2
    v_mul_f32 v77, v77, v2
    v_mul_f32 v78, v78, v2
    v_mul_f32 v79, v79, v2
    v_mul_f32 v80, v80, v2
    v_mul_f32 v81, v81, v2
    v_mul_f32 v82, v82, v2
    v_mul_f32 v83, v83, v2
    v_mul_f32 v84, v84, v2
    v_mul_f32 v85, v85, v2
    v_mul_f32 v86, v86, v2
    v_mul_f32 v87, v87, v2
    v_mul_f32 v88, v88, v2
    v_mul_f32 v89, v89, v2
    v_mul_f32 v90, v90, v2
    v_mul_f32 v91, v91, v2
    v_mul_f32 v92, v92, v2
    v_mul_f32 v93, v93, v2
    v_mul_f32 v94, v94, v2
    v_mul_f32 v95, v95, v2
    v_mul_f32 v96, v96, v2
    v_mul_f32 v97, v97, v2
    v_mul_f32 v98, v98, v2
    v_mul_f32 v99, v99, v2
    v_mul_f32 v100, v100, v2
    v_mul_f32 v101, v101, v2
    v_mul_f32 v102, v102, v2
    v_mul_f32 v103, v103, v2
    v_cvt_pk_bf16_f32 v104, v40, v41
    v_cvt_pk_bf16_f32 v105, v42, v43
    v_cvt_pk_bf16_f32 v106, v44, v45
    v_cvt_pk_bf16_f32 v107, v46, v47
    v_cvt_pk_bf16_f32 v108, v48, v49
    v_cvt_pk_bf16_f32 v109, v50, v51
    v_cvt_pk_bf16_f32 v110, v52, v53
    v_cvt_pk_bf16_f32 v111, v54, v55
    v_cvt_pk_bf16_f32 v112, v56, v57
    v_cvt_pk_bf16_f32 v113, v58, v59
    v_cvt_pk_bf16_f32 v114, v60, v61
    v_cvt_pk_bf16_f32 v115, v62, v63
    v_cvt_pk_bf16_f32 v116, v64, v65
    v_cvt_pk_bf16_f32 v117, v66, v67
    v_cvt_pk_bf16_f32 v118, v68, v69
    v_cvt_pk_bf16_f32 v119, v70, v71
    v_cvt_pk_bf16_f32 v120, v72, v73
    v_cvt_pk_bf16_f32 v121, v74, v75
    v_cvt_pk_bf16_f32 v122, v76, v77
    v_cvt_pk_bf16_f32 v123, v78, v79
    v_cvt_pk_bf16_f32 v124, v80, v81
    v_cvt_pk_bf16_f32 v125, v82, v83
    v_cvt_pk_bf16_f32 v126, v84, v85
    v_cvt_pk_bf16_f32 v127, v86, v87
    v_cvt_pk_bf16_f32 v128, v88, v89
    v_cvt_pk_bf16_f32 v129, v90, v91
    v_cvt_pk_bf16_f32 v130, v92, v93
    v_cvt_pk_bf16_f32 v131, v94, v95
    v_cvt_pk_bf16_f32 v132, v96, v97
    v_cvt_pk_bf16_f32 v133, v98, v99
    v_cvt_pk_bf16_f32 v134, v100, v101
    v_cvt_pk_bf16_f32 v135, v102, v103
    s_nop 1
    v_permlane32_swap_b32 v104, v106
    v_permlane32_swap_b32 v105, v107
    v_permlane32_swap_b32 v108, v110
    v_permlane32_swap_b32 v109, v111
    v_permlane32_swap_b32 v112, v114
    v_permlane32_swap_b32 v113, v115
    v_permlane32_swap_b32 v116, v118
    v_permlane32_swap_b32 v117, v119
    v_permlane32_swap_b32 v120, v122
    v_permlane32_swap_b32 v121, v123
    v_permlane32_swap_b32 v124, v126
    v_permlane32_swap_b32 v125, v127
    v_permlane32_swap_b32 v128, v130
    v_permlane32_swap_b32 v129, v131
    v_permlane32_swap_b32 v132, v134
    v_permlane32_swap_b32 v133, v135
    buffer_store_dwordx4 v[104:107], v237, s[16:19], 0 offen offset:0
    buffer_store_dwordx4 v[108:111], v237, s[16:19], 0 offen offset:32
    buffer_store_dwordx4 v[112:115], v237, s[16:19], 0 offen offset:64
    buffer_store_dwordx4 v[116:119], v237, s[16:19], 0 offen offset:96
    buffer_store_dwordx4 v[120:123], v237, s[16:19], 0 offen offset:128
    buffer_store_dwordx4 v[124:127], v237, s[16:19], 0 offen offset:160
    buffer_store_dwordx4 v[128:131], v237, s[16:19], 0 offen offset:192
    buffer_store_dwordx4 v[132:135], v237, s[16:19], 0 offen offset:224
    s_waitcnt vmcnt(0)
L_end:
s_endpgm
L_resc0:
    s_nop 15
    v_max_f32 v5, v5, v1
    v_sub_f32 v6, v1, v5
    v_mul_f32 v6, s25, v6
    v_exp_f32 v4, v6
    v_mul_f32 v238, s25, v5
    v_mov_b32 v1, v5
    v_mul_f32 v2, v2, v4
    v_mul_f32 v3, v3, v4
    v_mul_f32 v40, v40, v4
    v_mul_f32 v41, v41, v4
    v_mul_f32 v42, v42, v4
    v_mul_f32 v43, v43, v4
    v_mul_f32 v44, v44, v4
    v_mul_f32 v45, v45, v4
    v_mul_f32 v46, v46, v4
    v_mul_f32 v47, v47, v4
    v_mul_f32 v48, v48, v4
    v_mul_f32 v49, v49, v4
    v_mul_f32 v50, v50, v4
    v_mul_f32 v51, v51, v4
    v_mul_f32 v52, v52, v4
    v_mul_f32 v53, v53, v4
    v_mul_f32 v54, v54, v4
    v_mul_f32 v55, v55, v4
    v_mul_f32 v56, v56, v4
    v_mul_f32 v57, v57, v4
    v_mul_f32 v58, v58, v4
    v_mul_f32 v59, v59, v4
    v_mul_f32 v60, v60, v4
    v_mul_f32 v61, v61, v4
    v_mul_f32 v62, v62, v4
    v_mul_f32 v63, v63, v4
    v_mul_f32 v64, v64, v4
    v_mul_f32 v65, v65, v4
    v_mul_f32 v66, v66, v4
    v_mul_f32 v67, v67, v4
    v_mul_f32 v68, v68, v4
    v_mul_f32 v69, v69, v4
    v_mul_f32 v70, v70, v4
    v_mul_f32 v71, v71, v4
    v_mul_f32 v72, v72, v4
    v_mul_f32 v73, v73, v4
    v_mul_f32 v74, v74, v4
    v_mul_f32 v75, v75, v4
    v_mul_f32 v76, v76, v4
    v_mul_f32 v77, v77, v4
    v_mul_f32 v78, v78, v4
    v_mul_f32 v79, v79, v4
    v_mul_f32 v80, v80, v4
    v_mul_f32 v81, v81, v4
    v_mul_f32 v82, v82, v4
    v_mul_f32 v83, v83, v4
    v_mul_f32 v84, v84, v4
    v_mul_f32 v85, v85, v4
    v_mul_f32 v86, v86, v4
    v_mul_f32 v87, v87, v4
    v_mul_f32 v88, v88, v4
    v_mul_f32 v89, v89, v4
    v_mul_f32 v90, v90, v4
    v_mul_f32 v91, v91, v4
    v_mul_f32 v92, v92, v4
    v_mul_f32 v93, v93, v4
    v_mul_f32 v94, v94, v4
    v_mul_f32 v95, v95, v4
    v_mul_f32 v96, v96, v4
    v_mul_f32 v97, v97, v4
    v_mul_f32 v98, v98, v4
    v_mul_f32 v99, v99, v4
    v_mul_f32 v100, v100, v4
    v_mul_f32 v101, v101, v4
    v_mul_f32 v102, v102, v4
    v_mul_f32 v103, v103, v4
    s_nop 1
    s_branch L_back0
L_resc1:
    s_nop 15
    v_max_f32 v5, v5, v1
    v_sub_f32 v6, v1, v5
    v_mul_f32 v6, s25, v6
    v_exp_f32 v4, v6
    v_mul_f32 v238, s25, v5
    v_mov_b32 v1, v5
    v_mul_f32 v2, v2, v4
    v_mul_f32 v3, v3, v4
    v_mul_f32 v40, v40, v4
    v_mul_f32 v41, v41, v4
    v_mul_f32 v42, v42, v4
    v_mul_f32 v43, v43, v4
    v_mul_f32 v44, v44, v4
    v_mul_f32 v45, v45, v4
    v_mul_f32 v46, v46, v4
    v_mul_f32 v47, v47, v4
    v_mul_f32 v48, v48, v4
    v_mul_f32 v49, v49, v4
    v_mul_f32 v50, v50, v4
    v_mul_f32 v51, v51, v4
    v_mul_f32 v52, v52, v4
    v_mul_f32 v53, v53, v4
    v_mul_f32 v54, v54, v4
    v_mul_f32 v55, v55, v4
    v_mul_f32 v56, v56, v4
    v_mul_f32 v57, v57, v4
    v_mul_f32 v58, v58, v4
    v_mul_f32 v59, v59, v4
    v_mul_f32 v60, v60, v4
    v_mul_f32 v61, v61, v4
    v_mul_f32 v62, v62, v4
    v_mul_f32 v63, v63, v4
    v_mul_f32 v64, v64, v4
    v_mul_f32 v65, v65, v4
    v_mul_f32 v66, v66, v4
    v_mul_f32 v67, v67, v4
    v_mul_f32 v68, v68, v4
    v_mul_f32 v69, v69, v4
    v_mul_f32 v70, v70, v4
    v_mul_f32 v71, v71, v4
    v_mul_f32 v72, v72, v4
    v_mul_f32 v73, v73, v4
    v_mul_f32 v74, v74, v4
    v_mul_f32 v75, v75, v4
    v_mul_f32 v76, v76, v4
    v_mul_f32 v77, v77, v4
    v_mul_f32 v78, v78, v4
    v_mul_f32 v79, v79, v4
    v_mul_f32 v80, v80, v4
    v_mul_f32 v81, v81, v4
    v_mul_f32 v82, v82, v4
    v_mul_f32 v83, v83, v4
    v_mul_f32 v84, v84, v4
    v_mul_f32 v85, v85, v4
    v_mul_f32 v86, v86, v4
    v_mul_f32 v87, v87, v4
    v_mul_f32 v88, v88, v4
    v_mul_f32 v89, v89, v4
    v_mul_f32 v90, v90, v4
    v_mul_f32 v91, v91, v4
    v_mul_f32 v92, v92, v4
    v_mul_f32 v93, v93, v4
    v_mul_f32 v94, v94, v4
    v_mul_f32 v95, v95, v4
    v_mul_f32 v96, v96, v4
    v_mul_f32 v97, v97, v4
    v_mul_f32 v98, v98, v4
    v_mul_f32 v99, v99, v4
    v_mul_f32 v100, v100, v4
    v_mul_f32 v101, v101, v4
    v_mul_f32 v102, v102, v4
    v_mul_f32 v103, v103, v4
    s_nop 1
    s_branch L_back1
L_resc2:
    s_nop 15
    v_max_f32 v5, v5, v1
    v_sub_f32 v6, v1, v5
    v_mul_f32 v6, s25, v6
    v_exp_f32 v4, v6
    v_mul_f32 v238, s25, v5
    v_mov_b32 v1, v5
    v_mul_f32 v2, v2, v4
    v_mul_f32 v3, v3, v4
    v_mul_f32 v40, v40, v4
    v_mul_f32 v41, v41, v4
    v_mul_f32 v42, v42, v4
    v_mul_f32 v43, v43, v4
    v_mul_f32 v44, v44, v4
    v_mul_f32 v45, v45, v4
    v_mul_f32 v46, v46, v4
    v_mul_f32 v47, v47, v4
    v_mul_f32 v48, v48, v4
    v_mul_f32 v49, v49, v4
    v_mul_f32 v50, v50, v4
    v_mul_f32 v51, v51, v4
    v_mul_f32 v52, v52, v4
    v_mul_f32 v53, v53, v4
    v_mul_f32 v54, v54, v4
    v_mul_f32 v55, v55, v4
    v_mul_f32 v56, v56, v4
    v_mul_f32 v57, v57, v4
    v_mul_f32 v58, v58, v4
    v_mul_f32 v59, v59, v4
    v_mul_f32 v60, v60, v4
    v_mul_f32 v61, v61, v4
    v_mul_f32 v62, v62, v4
    v_mul_f32 v63, v63, v4
    v_mul_f32 v64, v64, v4
    v_mul_f32 v65, v65, v4
    v_mul_f32 v66, v66, v4
    v_mul_f32 v67, v67, v4
    v_mul_f32 v68, v68, v4
    v_mul_f32 v69, v69, v4
    v_mul_f32 v70, v70, v4
    v_mul_f32 v71, v71, v4
    v_mul_f32 v72, v72, v4
    v_mul_f32 v73, v73, v4
    v_mul_f32 v74, v74, v4
    v_mul_f32 v75, v75, v4
    v_mul_f32 v76, v76, v4
    v_mul_f32 v77, v77, v4
    v_mul_f32 v78, v78, v4
    v_mul_f32 v79, v79, v4
    v_mul_f32 v80, v80, v4
    v_mul_f32 v81, v81, v4
    v_mul_f32 v82, v82, v4
    v_mul_f32 v83, v83, v4
    v_mul_f32 v84, v84, v4
    v_mul_f32 v85, v85, v4
    v_mul_f32 v86, v86, v4
    v_mul_f32 v87, v87, v4
    v_mul_f32 v88, v88, v4
    v_mul_f32 v89, v89, v4
    v_mul_f32 v90, v90, v4
    v_mul_f32 v91, v91, v4
    v_mul_f32 v92, v92, v4
    v_mul_f32 v93, v93, v4
    v_mul_f32 v94, v94, v4
    v_mul_f32 v95, v95, v4
    v_mul_f32 v96, v96, v4
    v_mul_f32 v97, v97, v4
    v_mul_f32 v98, v98, v4
    v_mul_f32 v99, v99, v4
    v_mul_f32 v100, v100, v4
    v_mul_f32 v101, v101, v4
    v_mul_f32 v102, v102, v4
    v_mul_f32 v103, v103, v4
    s_nop 1
    s_branch L_back2
L_resc3:
    s_nop 15
    v_max_f32 v5, v5, v1
    v_sub_f32 v6, v1, v5
    v_mul_f32 v6, s25, v6
    v_exp_f32 v4, v6
    v_mul_f32 v238, s25, v5
    v_mov_b32 v1, v5
    v_mul_f32 v2, v2, v4
    v_mul_f32 v3, v3, v4
    v_mul_f32 v40, v40, v4
    v_mul_f32 v41, v41, v4
    v_mul_f32 v42, v42, v4
    v_mul_f32 v43, v43, v4
    v_mul_f32 v44, v44, v4
    v_mul_f32 v45, v45, v4
    v_mul_f32 v46, v46, v4
    v_mul_f32 v47, v47, v4
    v_mul_f32 v48, v48, v4
    v_mul_f32 v49, v49, v4
    v_mul_f32 v50, v50, v4
    v_mul_f32 v51, v51, v4
    v_mul_f32 v52, v52, v4
    v_mul_f32 v53, v53, v4
    v_mul_f32 v54, v54, v4
    v_mul_f32 v55, v55, v4
    v_mul_f32 v56, v56, v4
    v_mul_f32 v57, v57, v4
    v_mul_f32 v58, v58, v4
    v_mul_f32 v59, v59, v4
    v_mul_f32 v60, v60, v4
    v_mul_f32 v61, v61, v4
    v_mul_f32 v62, v62, v4
    v_mul_f32 v63, v63, v4
    v_mul_f32 v64, v64, v4
    v_mul_f32 v65, v65, v4
    v_mul_f32 v66, v66, v4
    v_mul_f32 v67, v67, v4
    v_mul_f32 v68, v68, v4
    v_mul_f32 v69, v69, v4
    v_mul_f32 v70, v70, v4
    v_mul_f32 v71, v71, v4
    v_mul_f32 v72, v72, v4
    v_mul_f32 v73, v73, v4
    v_mul_f32 v74, v74, v4
    v_mul_f32 v75, v75, v4
    v_mul_f32 v76, v76, v4
    v_mul_f32 v77, v77, v4
    v_mul_f32 v78, v78, v4
    v_mul_f32 v79, v79, v4
    v_mul_f32 v80, v80, v4
    v_mul_f32 v81, v81, v4
    v_mul_f32 v82, v82, v4
    v_mul_f32 v83, v83, v4
    v_mul_f32 v84, v84, v4
    v_mul_f32 v85, v85, v4
    v_mul_f32 v86, v86, v4
    v_mul_f32 v87, v87, v4
    v_mul_f32 v88, v88, v4
    v_mul_f32 v89, v89, v4
    v_mul_f32 v90, v90, v4
    v_mul_f32 v91, v91, v4
    v_mul_f32 v92, v92, v4
    v_mul_f32 v93, v93, v4
    v_mul_f32 v94, v94, v4
    v_mul_f32 v95, v95, v4
    v_mul_f32 v96, v96, v4
    v_mul_f32 v97, v97, v4
    v_mul_f32 v98, v98, v4
    v_mul_f32 v99, v99, v4
    v_mul_f32 v100, v100, v4
    v_mul_f32 v101, v101, v4
    v_mul_f32 v102, v102, v4
    v_mul_f32 v103, v103, v4
    s_nop 1
    s_branch L_back3
L_resc4:
    s_nop 15
    v_max_f32 v5, v5, v1
    v_sub_f32 v6, v1, v5
    v_mul_f32 v6, s25, v6
    v_exp_f32 v4, v6
    v_mul_f32 v238, s25, v5
    v_mov_b32 v1, v5
    v_mul_f32 v2, v2, v4
    v_mul_f32 v3, v3, v4
    v_mul_f32 v40, v40, v4
    v_mul_f32 v41, v41, v4
    v_mul_f32 v42, v42, v4
    v_mul_f32 v43, v43, v4
    v_mul_f32 v44, v44, v4
    v_mul_f32 v45, v45, v4
    v_mul_f32 v46, v46, v4
    v_mul_f32 v47, v47, v4
    v_mul_f32 v48, v48, v4
    v_mul_f32 v49, v49, v4
    v_mul_f32 v50, v50, v4
    v_mul_f32 v51, v51, v4
    v_mul_f32 v52, v52, v4
    v_mul_f32 v53, v53, v4
    v_mul_f32 v54, v54, v4
    v_mul_f32 v55, v55, v4
    v_mul_f32 v56, v56, v4
    v_mul_f32 v57, v57, v4
    v_mul_f32 v58, v58, v4
    v_mul_f32 v59, v59, v4
    v_mul_f32 v60, v60, v4
    v_mul_f32 v61, v61, v4
    v_mul_f32 v62, v62, v4
    v_mul_f32 v63, v63, v4
    v_mul_f32 v64, v64, v4
    v_mul_f32 v65, v65, v4
    v_mul_f32 v66, v66, v4
    v_mul_f32 v67, v67, v4
    v_mul_f32 v68, v68, v4
    v_mul_f32 v69, v69, v4
    v_mul_f32 v70, v70, v4
    v_mul_f32 v71, v71, v4
    v_mul_f32 v72, v72, v4
    v_mul_f32 v73, v73, v4
    v_mul_f32 v74, v74, v4
    v_mul_f32 v75, v75, v4
    v_mul_f32 v76, v76, v4
    v_mul_f32 v77, v77, v4
    v_mul_f32 v78, v78, v4
    v_mul_f32 v79, v79, v4
    v_mul_f32 v80, v80, v4
    v_mul_f32 v81, v81, v4
    v_mul_f32 v82, v82, v4
    v_mul_f32 v83, v83, v4
    v_mul_f32 v84, v84, v4
    v_mul_f32 v85, v85, v4
    v_mul_f32 v86, v86, v4
    v_mul_f32 v87, v87, v4
    v_mul_f32 v88, v88, v4
    v_mul_f32 v89, v89, v4
    v_mul_f32 v90, v90, v4
    v_mul_f32 v91, v91, v4
    v_mul_f32 v92, v92, v4
    v_mul_f32 v93, v93, v4
    v_mul_f32 v94, v94, v4
    v_mul_f32 v95, v95, v4
    v_mul_f32 v96, v96, v4
    v_mul_f32 v97, v97, v4
    v_mul_f32 v98, v98, v4
    v_mul_f32 v99, v99, v4
    v_mul_f32 v100, v100, v4
    v_mul_f32 v101, v101, v4
    v_mul_f32 v102, v102, v4
    v_mul_f32 v103, v103, v4
    s_nop 1
    s_branch L_back4
L_resc5:
    s_nop 15
    v_max_f32 v5, v5, v1
    v_sub_f32 v6, v1, v5
    v_mul_f32 v6, s25, v6
    v_exp_f32 v4, v6
    v_mul_f32 v238, s25, v5
    v_mov_b32 v1, v5
    v_mul_f32 v2, v2, v4
    v_mul_f32 v3, v3, v4
    v_mul_f32 v40, v40, v4
    v_mul_f32 v41, v41, v4
    v_mul_f32 v42, v42, v4
    v_mul_f32 v43, v43, v4
    v_mul_f32 v44, v44, v4
    v_mul_f32 v45, v45, v4
    v_mul_f32 v46, v46, v4
    v_mul_f32 v47, v47, v4
    v_mul_f32 v48, v48, v4
    v_mul_f32 v49, v49, v4
    v_mul_f32 v50, v50, v4
    v_mul_f32 v51, v51, v4
    v_mul_f32 v52, v52, v4
    v_mul_f32 v53, v53, v4
    v_mul_f32 v54, v54, v4
    v_mul_f32 v55, v55, v4
    v_mul_f32 v56, v56, v4
    v_mul_f32 v57, v57, v4
    v_mul_f32 v58, v58, v4
    v_mul_f32 v59, v59, v4
    v_mul_f32 v60, v60, v4
    v_mul_f32 v61, v61, v4
    v_mul_f32 v62, v62, v4
    v_mul_f32 v63, v63, v4
    v_mul_f32 v64, v64, v4
    v_mul_f32 v65, v65, v4
    v_mul_f32 v66, v66, v4
    v_mul_f32 v67, v67, v4
    v_mul_f32 v68, v68, v4
    v_mul_f32 v69, v69, v4
    v_mul_f32 v70, v70, v4
    v_mul_f32 v71, v71, v4
    v_mul_f32 v72, v72, v4
    v_mul_f32 v73, v73, v4
    v_mul_f32 v74, v74, v4
    v_mul_f32 v75, v75, v4
    v_mul_f32 v76, v76, v4
    v_mul_f32 v77, v77, v4
    v_mul_f32 v78, v78, v4
    v_mul_f32 v79, v79, v4
    v_mul_f32 v80, v80, v4
    v_mul_f32 v81, v81, v4
    v_mul_f32 v82, v82, v4
    v_mul_f32 v83, v83, v4
    v_mul_f32 v84, v84, v4
    v_mul_f32 v85, v85, v4
    v_mul_f32 v86, v86, v4
    v_mul_f32 v87, v87, v4
    v_mul_f32 v88, v88, v4
    v_mul_f32 v89, v89, v4
    v_mul_f32 v90, v90, v4
    v_mul_f32 v91, v91, v4
    v_mul_f32 v92, v92, v4
    v_mul_f32 v93, v93, v4
    v_mul_f32 v94, v94, v4
    v_mul_f32 v95, v95, v4
    v_mul_f32 v96, v96, v4
    v_mul_f32 v97, v97, v4
    v_mul_f32 v98, v98, v4
    v_mul_f32 v99, v99, v4
    v_mul_f32 v100, v100, v4
    v_mul_f32 v101, v101, v4
    v_mul_f32 v102, v102, v4
    v_mul_f32 v103, v103, v4
    s_nop 1
    s_branch L_back5
.section .rodata,"a"
.p2align 6
.amdhsa_kernel standalone__gqa_softmax__near_ridge_kernel
  .amdhsa_next_free_vgpr 251
  .amdhsa_next_free_sgpr 56
  .amdhsa_accum_offset 252
  .amdhsa_group_segment_fixed_size 0
  .amdhsa_kernarg_size 48
  .amdhsa_user_sgpr_count 2
  .amdhsa_user_sgpr_kernarg_segment_ptr 1
  .amdhsa_system_sgpr_workgroup_id_x 1
.end_amdhsa_kernel
```
